```python
import torch

def _softmax(x, axis=-1):
    return torch.softmax(x, dim=axis)
def _gelu(x):
    return torch.nn.functional.gelu(x, approximate="tanh")
def _silu(x):
    return torch.nn.functional.silu(x)
def _sigmoid(x):
    return torch.sigmoid(x)
def _layernorm(x, axis=-1, eps=1e-5):
    m = x.mean(dim=axis, keepdim=True)
    v = x.var(dim=axis, keepdim=True, unbiased=False)
    return (x - m) / torch.sqrt(v + eps)
def _scatter_add(tgt, idx, src, axis=0):
    return tgt.clone().index_add_(axis, idx, src)
def _segment_sum(src, seg, n):
    out = torch.zeros((n,) + src.shape[1:], dtype=src.dtype)
    return out.index_add_(0, seg, src)
def _pad(x, pw):
    flat = tuple(v for pair in reversed(pw) for v in pair)
    return torch.nn.functional.pad(x, flat)

kernel_name = 'gated_mix__sliding_local_dilated__dense_activation_gelu__prompt'

def setup_inputs():

    _w = (lambda a: (lambda t: t.to(torch.bfloat16) if t.is_floating_point() else t)(torch.as_tensor(a)))
    def _A_setup():
        B, S, D = 1, 2048, 512
        return {
            "x": _w((lambda *s: torch.randn(*s, dtype=torch.bfloat16) * 0.05)(B, S, D)),
            "wqkv": _w((lambda *s: torch.randn(*s, dtype=torch.bfloat16) * 0.8)(D, 3 * D)),
            "wo": _w((lambda *s: torch.randn(*s, dtype=torch.bfloat16) * 0.05)(D, D)),
        }
    _A_in = _A_setup()

    def _B_setup():
        B, S, D, F = 1, 2048, 512, 1792
        return {
            "x": _w((lambda *s: torch.randn(*s, dtype=torch.bfloat16) * 0.05)(B, S, D)),
            "w1": _w((lambda *s: torch.randn(*s, dtype=torch.bfloat16) * 12.8)(D, F) * (D ** -0.5)),
            "b1": _w((lambda *s: torch.randn(*s, dtype=torch.bfloat16) * 12.8)(F) * 0.01),
            "w2": _w((lambda *s: torch.randn(*s, dtype=torch.bfloat16) * 1.6)(F, D) * (F ** -0.5)),
            "b2": _w((lambda *s: torch.randn(*s, dtype=torch.bfloat16) * 12.8)(D) * 0.01),
        }
    _B_in = _B_setup()

    return {
        "A_x": _A_in["x"],
        "A_wqkv": _A_in["wqkv"],
        "A_wo": _A_in["wo"],
        "B_x": _B_in["x"],
        "B_w1": _B_in["w1"],
        "B_b1": _B_in["b1"],
        "B_w2": _B_in["w2"],
        "B_b2": _B_in["b2"],
        "gate_w": _w((lambda *s: torch.randn(*s, dtype=torch.bfloat16) * 0.05)(512) * 16.0),
    }

def reference(A_x, A_wqkv, A_wo, B_x, B_w1, B_b1, B_w2, B_b2, gate_w):
    def _A_ref(x, wqkv, wo):
        B, S, D = x.shape
        H = 32; Dh = D // H
        W, dil = 8, 2
        qkv = (lambda x, *d: x.permute(*d))((x @ wqkv).reshape(B, S, 3, H, Dh), 2, 0, 3, 1, 4)
        q, k, v = qkv[0], qkv[1], qkv[2]
        scale = Dh ** -0.5
        pos = torch.arange(S)
        off = torch.arange(W) * dil
        idx = pos[:, None] - off[None, :]
        mask = idx >= 0
        idx_c = torch.where(mask, idx, 0).reshape(-1)
        kg = k[:, :, idx_c, :].reshape(B, H, S, W, Dh)
        vg = v[:, :, idx_c, :].reshape(B, H, S, W, Dh)
        logits = torch.einsum("bhsd,bhswd->bhsw", q, kg) * scale
        logits = torch.where(mask[None, None, :, :], logits, -1e9)
        attn = _softmax(logits, axis=-1)
        o = torch.einsum("bhsw,bhswd->bhsd", attn, vg)
        return (lambda x, *d: x.permute(*d))(o, 0, 2, 1, 3).reshape(B, S, D) @ wo

    def _B_ref(x, w1, b1, w2, b2):
        h = torch.einsum("bsd,df->bsf", x, w1) + b1
        h = _gelu(h)
        return torch.einsum("bsf,fd->bsd", h, w2) + b2

    x = A_x
    g = _sigmoid((x * gate_w).sum(-1, keepdims=True))
    a = _A_ref(x, A_wqkv, A_wo)
    b = _B_ref(x, B_w1, B_b1, B_w2, B_b2)
    return g * a + (1 - g) * b
```

```asm
; @launch grid=(256,1,1) block=(512,1,1) lds=163840
.amdgcn_target "amdgcn-amd-amdhsa--gfx950"
.text
.globl gated_mix__sliding_local_dilated__dense_activation_gelu__prompt_kernel
.p2align 8
.type gated_mix__sliding_local_dilated__dense_activation_gelu__prompt_kernel,@function
gated_mix__sliding_local_dilated__dense_activation_gelu__prompt_kernel:
    s_cmp_ge_u32 s2, 256
    s_cbranch_scc1 L_end
    s_load_dwordx16 s[4:19], s[0:1], 0
    s_load_dwordx8 s[20:27], s[0:1], 64
    v_lshrrev_b32 v1, 6, v0
    v_and_b32 v0, 63, v0
    s_and_b32 s57, s2, 3
    v_readfirstlane_b32 s3, v1
    s_bfe_u32 s56, s2, 0x10002
    s_lshr_b32 s58, s2, 3
    v_lshrrev_b32 v8, 3, v0
    v_and_b32 v9, 7, v0
    v_lshrrev_b32 v10, 4, v0
    s_and_b32 s76, s3, 1
    s_lshl_b32 s77, s76, 2
    v_add_u32 v11, s77, v10
    v_xor_b32 v11, v11, v9
    v_lshlrev_b32 v11, 4, v11
    s_lshl_b32 s77, s3, 3
    v_add_u32 v12, s77, v8
    v_lshl_add_u32 v33, v12, 11, v11
    v_and_b32 v13, 1, v10
    s_lshl_b32 s64, s3, 10
    s_mul_i32 s65, s3, 6144
    s_mov_b32 s66, 0
    s_cmp_ge_u32 s58, 14
    s_cbranch_scc1 L_attn
    s_mul_i32 s77, s57, 14
    s_add_u32 s77, s77, s58
    s_lshr_b32 s59, s77, 3
    s_and_b32 s60, s77, 7
    s_lshl_b32 s61, s60, 7
    v_lshlrev_b32 v14, 2, v13
    v_xor_b32 v14, v14, v9
    v_lshlrev_b32 v14, 4, v14
    s_movk_i32 s77, 3584
    v_mad_u32_u24 v35, v12, s77, v14
    s_lshl_b32 s77, s59, 9
    v_add_u32 v35, s77, v35
    s_lshr_b32 s78, s3, 1
    s_lshl_b32 s78, s78, 7
    s_add_u32 s77, s77, s78
    v_lshrrev_b32 v14, 5, v0
    v_lshl_add_u32 v21, v14, 4, s77
    s_lshl_b32 s77, s61, 1
    s_add_u32 s77, s77, s56
    s_lshl_b32 s77, s77, 10
    v_add_u32 v33, s77, v33
    v_add_u32 v34, 0x20000, v33
    s_add_u32 s69, s60, s59
    s_and_b32 s69, s69, 7
    s_mul_i32 s69, s69, 1
    s_lshl_b32 s62, s69, 7
    s_mul_i32 s63, s62, 1792
    s_waitcnt lgkmcnt(0)
    s_mov_b32 s28, s4
    s_mov_b32 s29, s5
    s_mov_b32 s30, 2097152
    s_mov_b32 s31, 0x00020000
    s_mov_b32 s32, s12
    s_mov_b32 s33, s13
    s_mov_b32 s34, 1835008
    s_mov_b32 s35, 0x00020000
    s_mov_b32 s48, s14
    s_mov_b32 s49, s15
    s_mov_b32 s50, 3584
    s_mov_b32 s51, 0x00020000
    s_add_u32 m0, s64, 0
    s_nop 0
    buffer_load_dwordx4 v33, s[28:31], s62 offen lds
    s_add_u32 m0, s64, 8192
    s_nop 0
    buffer_load_dwordx4 v34, s[28:31], s62 offen lds
    s_add_u32 m0, s64, 16384
    s_add_u32 s62, s62, 128
    buffer_load_dwordx4 v35, s[32:35], s63 offen offset:0 lds
    s_add_u32 m0, s64, 24448
    s_and_b32 s62, s62, 1023
    buffer_load_dwordx4 v35, s[32:35], s63 offen offset:128 lds
    s_add_u32 m0, s64, 32512
    s_nop 0
    buffer_load_dwordx4 v35, s[32:35], s63 offen offset:256 lds
    s_add_u32 m0, s64, 40576
    s_nop 0
    buffer_load_dwordx4 v35, s[32:35], s63 offen offset:384 lds
    s_mul_i32 s63, s62, 1792
    buffer_load_dwordx4 v[104:107], v21, s[48:51], 0 offen offset:0
    buffer_load_dwordx4 v[108:111], v21, s[48:51], 0 offen offset:32
    buffer_load_dwordx4 v[112:115], v21, s[48:51], 0 offen offset:64
    buffer_load_dwordx4 v[116:119], v21, s[48:51], 0 offen offset:96
    s_barrier
    s_add_u32 m0, s64, 49152
    s_nop 0
    buffer_load_dwordx4 v33, s[28:31], s62 offen lds
    s_add_u32 m0, s64, 57344
    s_nop 0
    buffer_load_dwordx4 v34, s[28:31], s62 offen lds
    s_add_u32 m0, s64, 65536
    s_add_u32 s62, s62, 128
    buffer_load_dwordx4 v35, s[32:35], s63 offen offset:0 lds
    s_cmp_ge_u32 s58, 7
    s_cselect_b32 s67, 1, 0
    s_cselect_b32 s79, 7, 0
    s_sub_u32 s68, s58, s79
    s_cmp_ge_u32 s68, 3
    s_addc_u32 s68, s68, 0
    s_lshl_b32 s76, s67, 3
    s_lshr_b32 s70, 150994944, s76
    s_and_b32 s70, s70, 0xff
    s_mov_b32 s40, s26
    s_mov_b32 s41, s27
    s_mov_b32 s42, 16777216
    s_mov_b32 s43, 0x00020000
    s_mov_b32 s44, s22
    s_mov_b32 s45, s23
    s_mov_b32 s46, 2097152
    s_mov_b32 s47, 0x00020000
    s_mov_b32 s52, s24
    s_mov_b32 s53, s25
    s_mov_b32 s54, 256
    s_mov_b32 s55, 0x00020000
    s_mov_b32 s36, s16
    s_mov_b32 s37, s17
    s_mov_b32 s38, 1835008
    s_mov_b32 s39, 0x00020000
    s_lshl_b32 s77, s57, 2
    s_add_u32 s67, s67, s77
    s_lshl_b32 s67, s67, 6
    s_and_b32 s72, s3, 3
    s_mov_b32 s73, 147456
    s_lshl_b32 s78, s68, 7
    v_lshlrev_b32 v14, 2, v13
    v_xor_b32 v14, v14, v9
    v_lshlrev_b32 v14, 4, v14
    v_lshl_add_u32 v14, v8, 10, v14
    v_add_u32 v1, s78, v14
    v_lshl_add_u32 v254, v9, 4, s78
    v_lshrrev_b32 v14, 5, v0
    v_bfe_u32 v15, v0, 2, 2
    v_lshl_add_u32 v14, v14, 3, v15
    v_lshlrev_b32 v14, 7, v14
    v_lshrrev_b32 v15, 1, v15
    v_lshl_add_u32 v14, v15, 6, v14
    v_lshl_add_u32 v14, v13, 5, v14
    v_and_b32 v15, 3, v0
    v_lshl_add_u32 v16, v15, 3, v14
    v_add_u32 v2, s65, v16
    v_xor_b32 v3, 64, v2
    v_add_u32 v4, 0x10000, v2
    v_add_u32 v5, 0x10000, v3
    s_lshl_b32 s77, s56, 5
    s_lshr_b32 s78, s67, 5
    s_add_u32 s77, s77, s78
    s_mul_i32 s77, s77, s73
    v_lshl_add_u32 v252, v0, 4, s77
    v_add_u32 v253, s73, v252
    s_cmp_lt_u32 s3, 4
    s_cselect_b32 s76, 8, 4
    s_cselect_b32 s77, 10, 14
    s_cselect_b32 s80, 0, 72
    s_cselect_b32 s81, 32, 88
    s_mul_i32 s78, s72, s76
    s_add_u32 s78, s78, s80
    s_mul_i32 s79, s72, s77
    s_add_u32 s79, s79, s81
    s_mul_i32 s80, s68, s76
    s_lshr_b32 s80, s80, 3
    s_mul_i32 s81, s68, s77
    s_lshr_b32 s81, s81, 3
    s_sub_u32 s81, s81, s76
    v_min_u32 v16, 17, v0
    v_add_u32 v17, s80, v16
    v_subrev_u32 v18, s76, v17
    v_min_u32 v17, v17, v18
    v_add_u32 v17, s78, v17
    v_add_u32 v18, s81, v16
    v_subrev_u32 v19, s77, v18
    v_min_u32 v18, v18, v19
    v_cmp_gt_u32 vcc, s76, v16
    v_add_u32 v18, s79, v18
    s_nop 0
    v_cndmask_b32 v248, v18, v17, vcc
    v_add_u32 v16, s70, v16
    v_subrev_u32 v17, 18, v16
    v_min_u32 v16, v16, v17
    v_add_u32 v17, s80, v16
    v_subrev_u32 v18, s76, v17
    v_min_u32 v17, v17, v18
    v_add_u32 v17, s78, v17
    v_add_u32 v18, s81, v16
    v_subrev_u32 v19, s77, v18
    v_min_u32 v18, v18, v19
    v_cmp_gt_u32 vcc, s76, v16
    v_add_u32 v18, s79, v18
    s_nop 0
    v_cndmask_b32 v20, v18, v17, vcc
    v_lshlrev_b32 v248, 10, v248
    v_subrev_u32 v17, 32, v20
    v_subrev_u32 v18, 56, v17
    v_cmp_le_u32 vcc, 56, v17
    v_min_u32 v17, v17, v18
    v_and_b32 v18, -8, v17
    v_cndmask_b32 v19, 0, 8, vcc
    v_add3_u32 v17, v17, v18, v19
    v_cmp_gt_u32 vcc, 32, v20
    v_lshlrev_b32 v17, 14, v17
    v_lshl_or_b32 v18, v20, 14, 1
    v_cndmask_b32 v249, v17, v18, vcc
    s_lshl_b32 s80, s56, 4
    s_lshr_b32 s81, s67, 6
    s_add_u32 s80, s80, s81
    s_lshl_b32 s80, s80, 5
    s_mul_i32 s78, s72, s77
    s_add_u32 s79, s78, s77
    s_sub_u32 s79, s79, 1
    s_lshr_b32 s78, s78, 2
    s_lshr_b32 s79, s79, 2
    v_add_u32 v17, s78, v15
    v_min_u32 v17, s79, v17
    s_and_b32 s81, s3, 4
    s_lshl_b32 s81, s81, 2
    s_add_u32 s81, s81, s80
    v_add_u32 v17, s81, v17
    v_lshlrev_b32 v17, 7, v17
    v_add_u32 v251, 9502720, v17
    s_add_u32 s80, s80, s72
    s_add_u32 s80, s80, 10
    s_lshl_b32 s80, s80, 7
    s_add_u32 s80, s80, 9502720
    v_bfe_u32 v17, v0, 3, 1
    v_mul_u32_u24 v17, 48, v17
    v_add_u32 v17, s67, v17
    v_subrev_u32 v18, 16, v17
    v_max_i32 v18, 0, v18
    v_mul_u32_u24 v18, 586, v18
    v_lshrrev_b32 v18, 16, v18
    v_mul_u32_u24 v19, 112, v18
    v_sub_u32 v17, v17, v19
    v_lshrrev_b32 v17, 6, v17
    v_lshl_add_u32 v17, v18, 1, v17
    s_mul_i32 s78, s56, 18
    v_add_u32 v17, s78, v17
    s_lshl_b32 s78, s72, 3
    v_add_u32 v18, s78, v9
    v_cmp_eq_u32 vcc, 0, v13
    v_lshlrev_b32 v17, 5, v17
    s_nop 0
    v_cndmask_b32 v18, v15, v18, vcc
    v_add_u32 v17, v17, v18
    v_lshlrev_b32 v17, 7, v17
    v_add_u32 v17, 9633792, v17
    s_cmp_lt_u32 s3, 4
    s_cselect_b64 vcc, -1, 0
    v_mov_b32 v18, s80
    v_cndmask_b32 v250, v18, v17, vcc
    s_cmp_lg_u32 s3, 0
    s_cselect_b32 s77, 2147483648, 0
    v_min_u32 v7, 33, v0
    v_lshl_add_u32 v7, v7, 2, s77
    s_and_b32 s76, s3, 1
    s_lshl_b32 s77, s76, 13
    v_and_b32 v17, 31, v0
    v_bfe_u32 v18, v0, 1, 3
    v_lshrrev_b32 v19, 5, v0
    v_xor_b32 v18, v18, v19
    v_lshlrev_b32 v18, 4, v18
    v_lshl_add_u32 v18, v17, 7, v18
    v_add_u32 v21, s77, v18
    v_xor_b32 v22, 32, v21
    v_xor_b32 v23, 64, v21
    v_xor_b32 v24, 0x60, v21
    v_and_b32 v17, 1, v15
    v_lshrrev_b32 v18, 1, v15
    v_lshl_add_u32 v17, v17, 1, v18
    v_lshl_add_u32 v17, v17, 3, v14
    s_lshr_b32 s77, s3, 1
    s_lshl_b32 s78, s77, 13
    s_add_u32 s78, s78, 16384
    v_add_u32 v25, s78, v17
    v_xor_b32 v26, 64, v25
    v_add_u32 v27, 98304, v21
    v_add_u32 v28, 98304, v22
    v_add_u32 v29, 98304, v23
    v_add_u32 v30, 98304, v24
    v_add_u32 v31, 98304, v25
    v_add_u32 v32, 98304, v26
    s_lshl_b32 s78, s56, 4
    s_lshl_b32 s79, s60, 1
    s_add_u32 s78, s78, s79
    s_add_u32 s78, s78, s76
    s_and_b32 s77, s77, 1
    s_lshl_b32 s79, s59, 1
    s_add_u32 s77, s77, s79
    s_lshr_b32 s79, s3, 2
    s_lshl_b32 s80, s79, 4
    s_add_u32 s80, s80, s77
    s_lshl_b32 s81, s78, 5
    s_add_u32 s80, s80, s81
    s_lshl_b32 s80, s80, 7
    s_add_u32 s71, s80, 9502720
    s_mul_i32 s78, s78, 288
    s_mul_i32 s79, s79, 56
    s_lshl_b32 s77, s77, 2
    s_add_u32 s78, s78, s79
    s_add_u32 s78, s78, s77
    s_add_u32 s78, s78, 32
    s_lshl_b32 s78, s78, 10
    v_lshl_add_u32 v6, v0, 4, s78
    s_waitcnt vmcnt(3)
    s_barrier
    ds_read_b64_tr_b16 v[128:129], v25 offset:2048
    ds_read_b64_tr_b16 v[130:131], v25 offset:2560
    ds_read_b128 v[120:123], v22 offset:0
    ds_read_b64_tr_b16 v[132:133], v26 offset:2048
    ds_read_b64_tr_b16 v[134:135], v26 offset:2560
    ds_read_b128 v[124:127], v22 offset:4096
    v_lshlrev_b32 v40, 16, v104
    v_and_b32 v41, 0xffff0000, v104
    v_lshlrev_b32 v56, 16, v104
    v_and_b32 v57, 0xffff0000, v104
    v_lshlrev_b32 v42, 16, v105
    v_and_b32 v43, 0xffff0000, v105
    v_lshlrev_b32 v58, 16, v105
    v_and_b32 v59, 0xffff0000, v105
    v_lshlrev_b32 v44, 16, v106
    v_and_b32 v45, 0xffff0000, v106
    v_lshlrev_b32 v60, 16, v106
    v_and_b32 v61, 0xffff0000, v106
    v_lshlrev_b32 v46, 16, v107
    v_and_b32 v47, 0xffff0000, v107
    v_lshlrev_b32 v62, 16, v107
    v_and_b32 v63, 0xffff0000, v107
    v_lshlrev_b32 v48, 16, v108
    v_and_b32 v49, 0xffff0000, v108
    v_lshlrev_b32 v64, 16, v108
    v_and_b32 v65, 0xffff0000, v108
    v_lshlrev_b32 v50, 16, v109
    v_and_b32 v51, 0xffff0000, v109
    v_lshlrev_b32 v66, 16, v109
    v_and_b32 v67, 0xffff0000, v109
    v_lshlrev_b32 v52, 16, v110
    v_and_b32 v53, 0xffff0000, v110
    v_lshlrev_b32 v68, 16, v110
    v_and_b32 v69, 0xffff0000, v110
    v_lshlrev_b32 v54, 16, v111
    v_and_b32 v55, 0xffff0000, v111
    v_lshlrev_b32 v70, 16, v111
    v_and_b32 v71, 0xffff0000, v111
    v_lshlrev_b32 v72, 16, v112
    v_and_b32 v73, 0xffff0000, v112
    v_lshlrev_b32 v88, 16, v112
    v_and_b32 v89, 0xffff0000, v112
    v_lshlrev_b32 v74, 16, v113
    v_and_b32 v75, 0xffff0000, v113
    v_lshlrev_b32 v90, 16, v113
    v_and_b32 v91, 0xffff0000, v113
    v_lshlrev_b32 v76, 16, v114
    v_and_b32 v77, 0xffff0000, v114
    v_lshlrev_b32 v92, 16, v114
    v_and_b32 v93, 0xffff0000, v114
    v_lshlrev_b32 v78, 16, v115
    v_and_b32 v79, 0xffff0000, v115
    v_lshlrev_b32 v94, 16, v115
    v_and_b32 v95, 0xffff0000, v115
    v_lshlrev_b32 v80, 16, v116
    v_and_b32 v81, 0xffff0000, v116
    v_lshlrev_b32 v96, 16, v116
    v_and_b32 v97, 0xffff0000, v116
    v_lshlrev_b32 v82, 16, v117
    v_and_b32 v83, 0xffff0000, v117
    v_lshlrev_b32 v98, 16, v117
    v_and_b32 v99, 0xffff0000, v117
    v_lshlrev_b32 v84, 16, v118
    v_and_b32 v85, 0xffff0000, v118
    v_lshlrev_b32 v100, 16, v118
    v_and_b32 v101, 0xffff0000, v118
    v_lshlrev_b32 v86, 16, v119
    v_and_b32 v87, 0xffff0000, v119
    v_lshlrev_b32 v102, 16, v119
    v_and_b32 v103, 0xffff0000, v119
    ds_read_b64_tr_b16 v[112:113], v25 offset:0
    ds_read_b64_tr_b16 v[114:115], v25 offset:512
    ds_read_b128 v[104:107], v21 offset:0
    ds_read_b64_tr_b16 v[116:117], v26 offset:0
    ds_read_b64_tr_b16 v[118:119], v26 offset:512
    ds_read_b128 v[108:111], v21 offset:4096
    s_waitcnt lgkmcnt(0)
    v_mfma_f32_32x32x16_bf16 v[40:55], v[112:115], v[104:107], v[40:55]
    ds_read_b64_tr_b16 v[144:145], v25 offset:4096
    ds_read_b64_tr_b16 v[146:147], v25 offset:4608
    ds_read_b128 v[136:139], v23 offset:0
    v_mfma_f32_32x32x16_bf16 v[72:87], v[116:119], v[104:107], v[72:87]
    ds_read_b64_tr_b16 v[148:149], v26 offset:4096
    ds_read_b64_tr_b16 v[150:151], v26 offset:4608
    ds_read_b128 v[140:143], v23 offset:4096
    s_add_u32 m0, s64, 73600
    s_and_b32 s62, s62, 1023
    buffer_load_dwordx4 v35, s[32:35], s63 offen offset:128 lds
    v_mfma_f32_32x32x16_bf16 v[56:71], v[112:115], v[108:111], v[56:71]
    s_add_u32 m0, s64, 81664
    s_nop 0
    buffer_load_dwordx4 v35, s[32:35], s63 offen offset:256 lds
    s_add_u32 m0, s64, 89728
    s_nop 0
    buffer_load_dwordx4 v35, s[32:35], s63 offen offset:384 lds
    s_mul_i32 s63, s62, 1792
    v_mfma_f32_32x32x16_bf16 v[88:103], v[116:119], v[108:111], v[88:103]
    s_waitcnt lgkmcnt(6)
    v_mfma_f32_32x32x16_bf16 v[40:55], v[128:131], v[120:123], v[40:55]
    ds_read_b64_tr_b16 v[160:161], v25 offset:6144
    ds_read_b64_tr_b16 v[162:163], v25 offset:6656
    ds_read_b128 v[152:155], v24 offset:0
    v_mfma_f32_32x32x16_bf16 v[72:87], v[132:135], v[120:123], v[72:87]
    ds_read_b64_tr_b16 v[164:165], v26 offset:6144
    ds_read_b64_tr_b16 v[166:167], v26 offset:6656
    ds_read_b128 v[156:159], v24 offset:4096
    s_add_u32 m0, s64, 98304
    s_nop 0
    buffer_load_dwordx4 v33, s[28:31], s62 offen lds
    v_mfma_f32_32x32x16_bf16 v[56:71], v[128:131], v[124:127], v[56:71]
    s_add_u32 m0, s64, 106496
    s_nop 0
    buffer_load_dwordx4 v34, s[28:31], s62 offen lds
    s_add_u32 m0, s64, 114688
    s_add_u32 s62, s62, 128
    buffer_load_dwordx4 v35, s[32:35], s63 offen offset:0 lds
    v_mfma_f32_32x32x16_bf16 v[88:103], v[132:135], v[124:127], v[88:103]
    s_waitcnt lgkmcnt(6)
    v_mfma_f32_32x32x16_bf16 v[40:55], v[144:147], v[136:139], v[40:55]
    s_waitcnt vmcnt(3) lgkmcnt(0)
    s_barrier
    ds_read_b64_tr_b16 v[112:113], v25 offset:49152
    ds_read_b64_tr_b16 v[114:115], v25 offset:49664
    ds_read_b128 v[104:107], v21 offset:49152
    v_mfma_f32_32x32x16_bf16 v[72:87], v[148:151], v[136:139], v[72:87]
    ds_read_b64_tr_b16 v[116:117], v26 offset:49152
    ds_read_b64_tr_b16 v[118:119], v26 offset:49664
    ds_read_b128 v[108:111], v21 offset:53248
    s_add_u32 m0, s64, 122752
    s_and_b32 s62, s62, 1023
    buffer_load_dwordx4 v35, s[32:35], s63 offen offset:128 lds
    v_mfma_f32_32x32x16_bf16 v[56:71], v[144:147], v[140:143], v[56:71]
    s_add_u32 m0, s64, 130816
    s_nop 0
    buffer_load_dwordx4 v35, s[32:35], s63 offen offset:256 lds
    s_add_u32 m0, s64, 138880
    s_nop 0
    buffer_load_dwordx4 v35, s[32:35], s63 offen offset:384 lds
    s_mul_i32 s63, s62, 1792
    v_mfma_f32_32x32x16_bf16 v[88:103], v[148:151], v[140:143], v[88:103]
    s_waitcnt lgkmcnt(6)
    v_mfma_f32_32x32x16_bf16 v[40:55], v[160:163], v[152:155], v[40:55]
    ds_read_b64_tr_b16 v[128:129], v25 offset:51200
    ds_read_b64_tr_b16 v[130:131], v25 offset:51712
    ds_read_b128 v[120:123], v22 offset:49152
    v_mfma_f32_32x32x16_bf16 v[72:87], v[164:167], v[152:155], v[72:87]
    ds_read_b64_tr_b16 v[132:133], v26 offset:51200
    ds_read_b64_tr_b16 v[134:135], v26 offset:51712
    ds_read_b128 v[124:127], v22 offset:53248
    s_add_u32 m0, s64, 0
    s_nop 0
    buffer_load_dwordx4 v33, s[28:31], s62 offen lds
    v_mfma_f32_32x32x16_bf16 v[56:71], v[160:163], v[156:159], v[56:71]
    s_add_u32 m0, s64, 8192
    s_nop 0
    buffer_load_dwordx4 v34, s[28:31], s62 offen lds
    s_add_u32 m0, s64, 16384
    s_add_u32 s62, s62, 128
    buffer_load_dwordx4 v35, s[32:35], s63 offen offset:0 lds
    v_mfma_f32_32x32x16_bf16 v[88:103], v[164:167], v[156:159], v[88:103]
    s_waitcnt lgkmcnt(6)
    v_mfma_f32_32x32x16_bf16 v[40:55], v[112:115], v[104:107], v[40:55]
    ds_read_b64_tr_b16 v[144:145], v25 offset:53248
    ds_read_b64_tr_b16 v[146:147], v25 offset:53760
    ds_read_b128 v[136:139], v23 offset:49152
    v_mfma_f32_32x32x16_bf16 v[72:87], v[116:119], v[104:107], v[72:87]
    ds_read_b64_tr_b16 v[148:149], v26 offset:53248
    ds_read_b64_tr_b16 v[150:151], v26 offset:53760
    ds_read_b128 v[140:143], v23 offset:53248
    s_add_u32 m0, s64, 24448
    s_and_b32 s62, s62, 1023
    buffer_load_dwordx4 v35, s[32:35], s63 offen offset:128 lds
    v_mfma_f32_32x32x16_bf16 v[56:71], v[112:115], v[108:111], v[56:71]
    s_add_u32 m0, s64, 32512
    s_nop 0
    buffer_load_dwordx4 v35, s[32:35], s63 offen offset:256 lds
    s_add_u32 m0, s64, 40576
    s_nop 0
    buffer_load_dwordx4 v35, s[32:35], s63 offen offset:384 lds
    s_mul_i32 s63, s62, 1792
    v_mfma_f32_32x32x16_bf16 v[88:103], v[116:119], v[108:111], v[88:103]
    s_waitcnt lgkmcnt(6)
    v_mfma_f32_32x32x16_bf16 v[40:55], v[128:131], v[120:123], v[40:55]
    ds_read_b64_tr_b16 v[160:161], v25 offset:55296
    ds_read_b64_tr_b16 v[162:163], v25 offset:55808
    ds_read_b128 v[152:155], v24 offset:49152
    v_mfma_f32_32x32x16_bf16 v[72:87], v[132:135], v[120:123], v[72:87]
    ds_read_b64_tr_b16 v[164:165], v26 offset:55296
    ds_read_b64_tr_b16 v[166:167], v26 offset:55808
    ds_read_b128 v[156:159], v24 offset:53248
    v_mfma_f32_32x32x16_bf16 v[56:71], v[128:131], v[124:127], v[56:71]
    v_mfma_f32_32x32x16_bf16 v[88:103], v[132:135], v[124:127], v[88:103]
    s_waitcnt lgkmcnt(6)
    v_mfma_f32_32x32x16_bf16 v[40:55], v[144:147], v[136:139], v[40:55]
    s_waitcnt vmcnt(6) lgkmcnt(0)
    s_barrier
    ds_read_b64_tr_b16 v[112:113], v31 offset:0
    ds_read_b64_tr_b16 v[114:115], v31 offset:512
    ds_read_b128 v[104:107], v27 offset:0
    v_mfma_f32_32x32x16_bf16 v[72:87], v[148:151], v[136:139], v[72:87]
    ds_read_b64_tr_b16 v[116:117], v32 offset:0
    ds_read_b64_tr_b16 v[118:119], v32 offset:512
    ds_read_b128 v[108:111], v27 offset:4096
    s_add_u32 m0, s64, 49152
    s_nop 0
    buffer_load_dwordx4 v33, s[28:31], s62 offen lds
    v_mfma_f32_32x32x16_bf16 v[56:71], v[144:147], v[140:143], v[56:71]
    s_add_u32 m0, s64, 57344
    s_nop 0
    buffer_load_dwordx4 v34, s[28:31], s62 offen lds
    s_add_u32 m0, s64, 65536
    s_add_u32 s62, s62, 128
    buffer_load_dwordx4 v35, s[32:35], s63 offen offset:0 lds
    v_mfma_f32_32x32x16_bf16 v[88:103], v[148:151], v[140:143], v[88:103]
    s_waitcnt lgkmcnt(6)
    v_mfma_f32_32x32x16_bf16 v[40:55], v[160:163], v[152:155], v[40:55]
    ds_read_b64_tr_b16 v[128:129], v31 offset:2048
    ds_read_b64_tr_b16 v[130:131], v31 offset:2560
    ds_read_b128 v[120:123], v28 offset:0
    v_mfma_f32_32x32x16_bf16 v[72:87], v[164:167], v[152:155], v[72:87]
    ds_read_b64_tr_b16 v[132:133], v32 offset:2048
    ds_read_b64_tr_b16 v[134:135], v32 offset:2560
    ds_read_b128 v[124:127], v28 offset:4096
    s_add_u32 m0, s64, 73600
    s_and_b32 s62, s62, 1023
    buffer_load_dwordx4 v35, s[32:35], s63 offen offset:128 lds
    v_mfma_f32_32x32x16_bf16 v[56:71], v[160:163], v[156:159], v[56:71]
    s_add_u32 m0, s64, 81664
    s_nop 0
    buffer_load_dwordx4 v35, s[32:35], s63 offen offset:256 lds
    s_add_u32 m0, s64, 89728
    s_nop 0
    buffer_load_dwordx4 v35, s[32:35], s63 offen offset:384 lds
    s_mul_i32 s63, s62, 1792
    v_mfma_f32_32x32x16_bf16 v[88:103], v[164:167], v[156:159], v[88:103]
    s_waitcnt lgkmcnt(6)
    v_mfma_f32_32x32x16_bf16 v[40:55], v[112:115], v[104:107], v[40:55]
    ds_read_b64_tr_b16 v[144:145], v31 offset:4096
    ds_read_b64_tr_b16 v[146:147], v31 offset:4608
    ds_read_b128 v[136:139], v29 offset:0
    v_mfma_f32_32x32x16_bf16 v[72:87], v[116:119], v[104:107], v[72:87]
    ds_read_b64_tr_b16 v[148:149], v32 offset:4096
    ds_read_b64_tr_b16 v[150:151], v32 offset:4608
    ds_read_b128 v[140:143], v29 offset:4096
    v_mfma_f32_32x32x16_bf16 v[56:71], v[112:115], v[108:111], v[56:71]
    v_mfma_f32_32x32x16_bf16 v[88:103], v[116:119], v[108:111], v[88:103]
    s_waitcnt lgkmcnt(6)
    v_mfma_f32_32x32x16_bf16 v[40:55], v[128:131], v[120:123], v[40:55]
    ds_read_b64_tr_b16 v[160:161], v31 offset:6144
    ds_read_b64_tr_b16 v[162:163], v31 offset:6656
    ds_read_b128 v[152:155], v30 offset:0
    v_mfma_f32_32x32x16_bf16 v[72:87], v[132:135], v[120:123], v[72:87]
    ds_read_b64_tr_b16 v[164:165], v32 offset:6144
    ds_read_b64_tr_b16 v[166:167], v32 offset:6656
    ds_read_b128 v[156:159], v30 offset:4096
    v_mfma_f32_32x32x16_bf16 v[56:71], v[128:131], v[124:127], v[56:71]
    v_mfma_f32_32x32x16_bf16 v[88:103], v[132:135], v[124:127], v[88:103]
    s_waitcnt lgkmcnt(6)
    v_mfma_f32_32x32x16_bf16 v[40:55], v[144:147], v[136:139], v[40:55]
    s_waitcnt vmcnt(6) lgkmcnt(0)
    s_barrier
    ds_read_b64_tr_b16 v[112:113], v25 offset:0
    ds_read_b64_tr_b16 v[114:115], v25 offset:512
    ds_read_b128 v[104:107], v21 offset:0
    v_mfma_f32_32x32x16_bf16 v[72:87], v[148:151], v[136:139], v[72:87]
    ds_read_b64_tr_b16 v[116:117], v26 offset:0
    ds_read_b64_tr_b16 v[118:119], v26 offset:512
    ds_read_b128 v[108:111], v21 offset:4096
    s_add_u32 m0, s64, 98304
    s_nop 0
    buffer_load_dwordx4 v33, s[28:31], s62 offen lds
    v_mfma_f32_32x32x16_bf16 v[56:71], v[144:147], v[140:143], v[56:71]
    s_add_u32 m0, s64, 106496
    s_nop 0
    buffer_load_dwordx4 v34, s[28:31], s62 offen lds
    s_add_u32 m0, s64, 114688
    s_add_u32 s62, s62, 128
    buffer_load_dwordx4 v35, s[32:35], s63 offen offset:0 lds
    v_mfma_f32_32x32x16_bf16 v[88:103], v[148:151], v[140:143], v[88:103]
    s_waitcnt lgkmcnt(6)
    v_mfma_f32_32x32x16_bf16 v[40:55], v[160:163], v[152:155], v[40:55]
    ds_read_b64_tr_b16 v[128:129], v25 offset:2048
    ds_read_b64_tr_b16 v[130:131], v25 offset:2560
    ds_read_b128 v[120:123], v22 offset:0
    v_mfma_f32_32x32x16_bf16 v[72:87], v[164:167], v[152:155], v[72:87]
    ds_read_b64_tr_b16 v[132:133], v26 offset:2048
    ds_read_b64_tr_b16 v[134:135], v26 offset:2560
    ds_read_b128 v[124:127], v22 offset:4096
    s_add_u32 m0, s64, 122752
    s_and_b32 s62, s62, 1023
    buffer_load_dwordx4 v35, s[32:35], s63 offen offset:128 lds
    v_mfma_f32_32x32x16_bf16 v[56:71], v[160:163], v[156:159], v[56:71]
    s_add_u32 m0, s64, 130816
    s_nop 0
    buffer_load_dwordx4 v35, s[32:35], s63 offen offset:256 lds
    s_add_u32 m0, s64, 138880
    s_nop 0
    buffer_load_dwordx4 v35, s[32:35], s63 offen offset:384 lds
    s_mul_i32 s63, s62, 1792
    v_mfma_f32_32x32x16_bf16 v[88:103], v[164:167], v[156:159], v[88:103]
    s_waitcnt lgkmcnt(6)
    v_mfma_f32_32x32x16_bf16 v[40:55], v[112:115], v[104:107], v[40:55]
    ds_read_b64_tr_b16 v[144:145], v25 offset:4096
    ds_read_b64_tr_b16 v[146:147], v25 offset:4608
    ds_read_b128 v[136:139], v23 offset:0
    v_mfma_f32_32x32x16_bf16 v[72:87], v[116:119], v[104:107], v[72:87]
    ds_read_b64_tr_b16 v[148:149], v26 offset:4096
    ds_read_b64_tr_b16 v[150:151], v26 offset:4608
    ds_read_b128 v[140:143], v23 offset:4096
    v_mfma_f32_32x32x16_bf16 v[56:71], v[112:115], v[108:111], v[56:71]
    v_mfma_f32_32x32x16_bf16 v[88:103], v[116:119], v[108:111], v[88:103]
    s_waitcnt lgkmcnt(6)
    v_mfma_f32_32x32x16_bf16 v[40:55], v[128:131], v[120:123], v[40:55]
    ds_read_b64_tr_b16 v[160:161], v25 offset:6144
    ds_read_b64_tr_b16 v[162:163], v25 offset:6656
    ds_read_b128 v[152:155], v24 offset:0
    v_mfma_f32_32x32x16_bf16 v[72:87], v[132:135], v[120:123], v[72:87]
    ds_read_b64_tr_b16 v[164:165], v26 offset:6144
    ds_read_b64_tr_b16 v[166:167], v26 offset:6656
    ds_read_b128 v[156:159], v24 offset:4096
    buffer_load_dword v7, v7, s[52:55], 0 offen sc1
    v_mfma_f32_32x32x16_bf16 v[56:71], v[128:131], v[124:127], v[56:71]
    v_mfma_f32_32x32x16_bf16 v[88:103], v[132:135], v[124:127], v[88:103]
    s_waitcnt lgkmcnt(6)
    v_mfma_f32_32x32x16_bf16 v[40:55], v[144:147], v[136:139], v[40:55]
    s_waitcnt vmcnt(7) lgkmcnt(0)
    s_barrier
    ds_read_b64_tr_b16 v[112:113], v25 offset:49152
    ds_read_b64_tr_b16 v[114:115], v25 offset:49664
    ds_read_b128 v[104:107], v21 offset:49152
    v_mfma_f32_32x32x16_bf16 v[72:87], v[148:151], v[136:139], v[72:87]
    ds_read_b64_tr_b16 v[116:117], v26 offset:49152
    ds_read_b64_tr_b16 v[118:119], v26 offset:49664
    ds_read_b128 v[108:111], v21 offset:53248
    s_add_u32 m0, s64, 0
    s_nop 0
    buffer_load_dwordx4 v33, s[28:31], s62 offen lds
    v_mfma_f32_32x32x16_bf16 v[56:71], v[144:147], v[140:143], v[56:71]
    s_add_u32 m0, s64, 8192
    s_nop 0
    buffer_load_dwordx4 v34, s[28:31], s62 offen lds
    s_add_u32 m0, s64, 16384
    s_add_u32 s62, s62, 128
    buffer_load_dwordx4 v35, s[32:35], s63 offen offset:0 lds
    v_mfma_f32_32x32x16_bf16 v[88:103], v[148:151], v[140:143], v[88:103]
    s_waitcnt lgkmcnt(6)
    v_mfma_f32_32x32x16_bf16 v[40:55], v[160:163], v[152:155], v[40:55]
    ds_read_b64_tr_b16 v[128:129], v25 offset:51200
    ds_read_b64_tr_b16 v[130:131], v25 offset:51712
    ds_read_b128 v[120:123], v22 offset:49152
    v_mfma_f32_32x32x16_bf16 v[72:87], v[164:167], v[152:155], v[72:87]
    ds_read_b64_tr_b16 v[132:133], v26 offset:51200
    ds_read_b64_tr_b16 v[134:135], v26 offset:51712
    ds_read_b128 v[124:127], v22 offset:53248
    s_add_u32 m0, s64, 24448
    s_and_b32 s62, s62, 1023
    buffer_load_dwordx4 v35, s[32:35], s63 offen offset:128 lds
    v_mfma_f32_32x32x16_bf16 v[56:71], v[160:163], v[156:159], v[56:71]
    s_add_u32 m0, s64, 32512
    s_nop 0
    buffer_load_dwordx4 v35, s[32:35], s63 offen offset:256 lds
    s_add_u32 m0, s64, 40576
    s_nop 0
    buffer_load_dwordx4 v35, s[32:35], s63 offen offset:384 lds
    s_mul_i32 s63, s62, 1792
    v_mfma_f32_32x32x16_bf16 v[88:103], v[164:167], v[156:159], v[88:103]
    s_waitcnt lgkmcnt(6)
    v_mfma_f32_32x32x16_bf16 v[40:55], v[112:115], v[104:107], v[40:55]
    ds_read_b64_tr_b16 v[144:145], v25 offset:53248
    ds_read_b64_tr_b16 v[146:147], v25 offset:53760
    ds_read_b128 v[136:139], v23 offset:49152
    v_mfma_f32_32x32x16_bf16 v[72:87], v[116:119], v[104:107], v[72:87]
    ds_read_b64_tr_b16 v[148:149], v26 offset:53248
    ds_read_b64_tr_b16 v[150:151], v26 offset:53760
    ds_read_b128 v[140:143], v23 offset:53248
    v_mfma_f32_32x32x16_bf16 v[56:71], v[112:115], v[108:111], v[56:71]
    v_mfma_f32_32x32x16_bf16 v[88:103], v[116:119], v[108:111], v[88:103]
    s_waitcnt lgkmcnt(6)
    v_mfma_f32_32x32x16_bf16 v[40:55], v[128:131], v[120:123], v[40:55]
    ds_read_b64_tr_b16 v[160:161], v25 offset:55296
    ds_read_b64_tr_b16 v[162:163], v25 offset:55808
    ds_read_b128 v[152:155], v24 offset:49152
    v_mfma_f32_32x32x16_bf16 v[72:87], v[132:135], v[120:123], v[72:87]
    ds_read_b64_tr_b16 v[164:165], v26 offset:55296
    ds_read_b64_tr_b16 v[166:167], v26 offset:55808
    ds_read_b128 v[156:159], v24 offset:53248
    v_mfma_f32_32x32x16_bf16 v[56:71], v[128:131], v[124:127], v[56:71]
    v_mfma_f32_32x32x16_bf16 v[88:103], v[132:135], v[124:127], v[88:103]
    s_waitcnt lgkmcnt(6)
    v_mfma_f32_32x32x16_bf16 v[40:55], v[144:147], v[136:139], v[40:55]
    s_waitcnt vmcnt(7) lgkmcnt(0)
    s_barrier
    ds_read_b64_tr_b16 v[112:113], v31 offset:0
    ds_read_b64_tr_b16 v[114:115], v31 offset:512
    ds_read_b128 v[104:107], v27 offset:0
    v_mfma_f32_32x32x16_bf16 v[72:87], v[148:151], v[136:139], v[72:87]
    ds_read_b64_tr_b16 v[116:117], v32 offset:0
    ds_read_b64_tr_b16 v[118:119], v32 offset:512
    ds_read_b128 v[108:111], v27 offset:4096
    s_add_u32 m0, s64, 49152
    s_nop 0
    buffer_load_dwordx4 v33, s[28:31], s62 offen lds
    v_mfma_f32_32x32x16_bf16 v[56:71], v[144:147], v[140:143], v[56:71]
    s_add_u32 m0, s64, 57344
    s_nop 0
    buffer_load_dwordx4 v34, s[28:31], s62 offen lds
    s_add_u32 m0, s64, 65536
    s_add_u32 s62, s62, 128
    buffer_load_dwordx4 v35, s[32:35], s63 offen offset:0 lds
    v_mfma_f32_32x32x16_bf16 v[88:103], v[148:151], v[140:143], v[88:103]
    s_waitcnt lgkmcnt(6)
    v_mfma_f32_32x32x16_bf16 v[40:55], v[160:163], v[152:155], v[40:55]
    ds_read_b64_tr_b16 v[128:129], v31 offset:2048
    ds_read_b64_tr_b16 v[130:131], v31 offset:2560
    ds_read_b128 v[120:123], v28 offset:0
    v_mfma_f32_32x32x16_bf16 v[72:87], v[164:167], v[152:155], v[72:87]
    ds_read_b64_tr_b16 v[132:133], v32 offset:2048
    ds_read_b64_tr_b16 v[134:135], v32 offset:2560
    ds_read_b128 v[124:127], v28 offset:4096
    s_add_u32 m0, s64, 73600
    s_and_b32 s62, s62, 1023
    buffer_load_dwordx4 v35, s[32:35], s63 offen offset:128 lds
    v_mfma_f32_32x32x16_bf16 v[56:71], v[160:163], v[156:159], v[56:71]
    s_add_u32 m0, s64, 81664
    s_nop 0
    buffer_load_dwordx4 v35, s[32:35], s63 offen offset:256 lds
    s_add_u32 m0, s64, 89728
    s_nop 0
    buffer_load_dwordx4 v35, s[32:35], s63 offen offset:384 lds
    s_mul_i32 s63, s62, 1792
    v_mfma_f32_32x32x16_bf16 v[88:103], v[164:167], v[156:159], v[88:103]
    s_waitcnt lgkmcnt(6)
    v_mfma_f32_32x32x16_bf16 v[40:55], v[112:115], v[104:107], v[40:55]
    ds_read_b64_tr_b16 v[144:145], v31 offset:4096
    ds_read_b64_tr_b16 v[146:147], v31 offset:4608
    ds_read_b128 v[136:139], v29 offset:0
    v_mfma_f32_32x32x16_bf16 v[72:87], v[116:119], v[104:107], v[72:87]
    ds_read_b64_tr_b16 v[148:149], v32 offset:4096
    ds_read_b64_tr_b16 v[150:151], v32 offset:4608
    ds_read_b128 v[140:143], v29 offset:4096
    v_mfma_f32_32x32x16_bf16 v[56:71], v[112:115], v[108:111], v[56:71]
    v_mfma_f32_32x32x16_bf16 v[88:103], v[116:119], v[108:111], v[88:103]
    s_waitcnt lgkmcnt(6)
    v_mfma_f32_32x32x16_bf16 v[40:55], v[128:131], v[120:123], v[40:55]
    ds_read_b64_tr_b16 v[160:161], v31 offset:6144
    ds_read_b64_tr_b16 v[162:163], v31 offset:6656
    ds_read_b128 v[152:155], v30 offset:0
    v_mfma_f32_32x32x16_bf16 v[72:87], v[132:135], v[120:123], v[72:87]
    ds_read_b64_tr_b16 v[164:165], v32 offset:6144
    ds_read_b64_tr_b16 v[166:167], v32 offset:6656
    ds_read_b128 v[156:159], v30 offset:4096
    v_mfma_f32_32x32x16_bf16 v[56:71], v[128:131], v[124:127], v[56:71]
    v_mfma_f32_32x32x16_bf16 v[88:103], v[132:135], v[124:127], v[88:103]
    s_waitcnt lgkmcnt(6)
    v_mfma_f32_32x32x16_bf16 v[40:55], v[144:147], v[136:139], v[40:55]
    s_waitcnt vmcnt(6) lgkmcnt(0)
    s_cmp_lg_u32 s3, 0
    s_cbranch_scc1 L_f_e1
L_f_e0:
    v_cmp_ne_u32 vcc, 1, v7
    s_cbranch_vccz L_f_e1
    s_add_u32 s66, s66, 1
    s_cmp_ge_u32 s66, 262144
    s_cbranch_scc1 L_f_e1
    v_min_u32 v7, 33, v0
    v_lshlrev_b32 v7, 2, v7
    buffer_load_dword v7, v7, s[52:55], 0 offen sc1
    s_waitcnt vmcnt(0)
    s_branch L_f_e0
L_f_e1:
    s_barrier
    ds_read_b64_tr_b16 v[112:113], v25 offset:0
    ds_read_b64_tr_b16 v[114:115], v25 offset:512
    ds_read_b128 v[104:107], v21 offset:0
    v_mfma_f32_32x32x16_bf16 v[72:87], v[148:151], v[136:139], v[72:87]
    ds_read_b64_tr_b16 v[116:117], v26 offset:0
    ds_read_b64_tr_b16 v[118:119], v26 offset:512
    ds_read_b128 v[108:111], v21 offset:4096
    v_readlane_b32 s80, v249, 0
    s_add_u32 m0, s65, 98304
    s_bitcmp1_b32 s80, 0
    s_cselect_b32 s36, s8, s16
    s_cselect_b32 s37, s9, s17
    s_and_b32 s81, s80, -2
    buffer_load_dwordx4 v1, s[36:39], s81 offen lds
    v_mfma_f32_32x32x16_bf16 v[56:71], v[144:147], v[140:143], v[56:71]
    s_add_u32 m0, s65, 99328
    s_add_u32 s81, s81, 8192
    buffer_load_dwordx4 v1, s[36:39], s81 offen lds
    v_readlane_b32 s80, v249, 1
    s_add_u32 m0, s65, 100352
    s_bitcmp1_b32 s80, 0
    s_cselect_b32 s36, s8, s16
    s_cselect_b32 s37, s9, s17
    s_and_b32 s81, s80, -2
    buffer_load_dwordx4 v1, s[36:39], s81 offen lds
    v_mfma_f32_32x32x16_bf16 v[88:103], v[148:151], v[140:143], v[88:103]
    s_waitcnt lgkmcnt(6)
    v_mfma_f32_32x32x16_bf16 v[40:55], v[160:163], v[152:155], v[40:55]
    ds_read_b64_tr_b16 v[128:129], v25 offset:2048
    ds_read_b64_tr_b16 v[130:131], v25 offset:2560
    ds_read_b128 v[120:123], v22 offset:0
    v_mfma_f32_32x32x16_bf16 v[72:87], v[164:167], v[152:155], v[72:87]
    ds_read_b64_tr_b16 v[132:133], v26 offset:2048
    ds_read_b64_tr_b16 v[134:135], v26 offset:2560
    ds_read_b128 v[124:127], v22 offset:4096
    s_add_u32 m0, s65, 101376
    s_add_u32 s81, s81, 8192
    buffer_load_dwordx4 v1, s[36:39], s81 offen lds
    v_mfma_f32_32x32x16_bf16 v[56:71], v[160:163], v[156:159], v[56:71]
    v_readlane_b32 s80, v249, 2
    s_add_u32 m0, s65, 102400
    s_bitcmp1_b32 s80, 0
    s_cselect_b32 s36, s8, s16
    s_cselect_b32 s37, s9, s17
    s_and_b32 s81, s80, -2
    buffer_load_dwordx4 v1, s[36:39], s81 offen lds
    s_add_u32 m0, s65, 103424
    s_add_u32 s81, s81, 8192
    buffer_load_dwordx4 v1, s[36:39], s81 offen lds
    v_mfma_f32_32x32x16_bf16 v[88:103], v[164:167], v[156:159], v[88:103]
    s_waitcnt lgkmcnt(6)
    v_mfma_f32_32x32x16_bf16 v[40:55], v[112:115], v[104:107], v[40:55]
    ds_read_b64_tr_b16 v[144:145], v25 offset:4096
    ds_read_b64_tr_b16 v[146:147], v25 offset:4608
    ds_read_b128 v[136:139], v23 offset:0
    v_mfma_f32_32x32x16_bf16 v[72:87], v[116:119], v[104:107], v[72:87]
    ds_read_b64_tr_b16 v[148:149], v26 offset:4096
    ds_read_b64_tr_b16 v[150:151], v26 offset:4608
    ds_read_b128 v[140:143], v23 offset:4096
    v_mfma_f32_32x32x16_bf16 v[56:71], v[112:115], v[108:111], v[56:71]
    v_mfma_f32_32x32x16_bf16 v[88:103], v[116:119], v[108:111], v[88:103]
    s_waitcnt lgkmcnt(6)
    v_mfma_f32_32x32x16_bf16 v[40:55], v[128:131], v[120:123], v[40:55]
    ds_read_b64_tr_b16 v[160:161], v25 offset:6144
    ds_read_b64_tr_b16 v[162:163], v25 offset:6656
    ds_read_b128 v[152:155], v24 offset:0
    v_mfma_f32_32x32x16_bf16 v[72:87], v[132:135], v[120:123], v[72:87]
    ds_read_b64_tr_b16 v[164:165], v26 offset:6144
    ds_read_b64_tr_b16 v[166:167], v26 offset:6656
    ds_read_b128 v[156:159], v24 offset:4096
    v_mfma_f32_32x32x16_bf16 v[56:71], v[128:131], v[124:127], v[56:71]
    v_mfma_f32_32x32x16_bf16 v[88:103], v[132:135], v[124:127], v[88:103]
    s_waitcnt lgkmcnt(6)
    v_mfma_f32_32x32x16_bf16 v[40:55], v[144:147], v[136:139], v[40:55]
    s_waitcnt vmcnt(6) lgkmcnt(0)
    s_barrier
    ds_read_b64_tr_b16 v[112:113], v25 offset:49152
    ds_read_b64_tr_b16 v[114:115], v25 offset:49664
    ds_read_b128 v[104:107], v21 offset:49152
    v_mfma_f32_32x32x16_bf16 v[72:87], v[148:151], v[136:139], v[72:87]
    ds_read_b64_tr_b16 v[116:117], v26 offset:49152
    ds_read_b64_tr_b16 v[118:119], v26 offset:49664
    ds_read_b128 v[108:111], v21 offset:53248
    v_readlane_b32 s80, v249, 3
    s_add_u32 m0, s65, 0
    s_bitcmp1_b32 s80, 0
    s_cselect_b32 s36, s8, s16
    s_cselect_b32 s37, s9, s17
    s_and_b32 s81, s80, -2
    buffer_load_dwordx4 v1, s[36:39], s81 offen lds
    v_mfma_f32_32x32x16_bf16 v[56:71], v[144:147], v[140:143], v[56:71]
    s_add_u32 m0, s65, 1024
    s_add_u32 s81, s81, 8192
    buffer_load_dwordx4 v1, s[36:39], s81 offen lds
    v_readlane_b32 s80, v249, 4
    s_add_u32 m0, s65, 2048
    s_bitcmp1_b32 s80, 0
    s_cselect_b32 s36, s8, s16
    s_cselect_b32 s37, s9, s17
    s_and_b32 s81, s80, -2
    buffer_load_dwordx4 v1, s[36:39], s81 offen lds
    v_mfma_f32_32x32x16_bf16 v[88:103], v[148:151], v[140:143], v[88:103]
    s_waitcnt lgkmcnt(6)
    v_mfma_f32_32x32x16_bf16 v[40:55], v[160:163], v[152:155], v[40:55]
    ds_read_b64_tr_b16 v[128:129], v25 offset:51200
    ds_read_b64_tr_b16 v[130:131], v25 offset:51712
    ds_read_b128 v[120:123], v22 offset:49152
    v_mfma_f32_32x32x16_bf16 v[72:87], v[164:167], v[152:155], v[72:87]
    ds_read_b64_tr_b16 v[132:133], v26 offset:51200
    ds_read_b64_tr_b16 v[134:135], v26 offset:51712
    ds_read_b128 v[124:127], v22 offset:53248
    s_add_u32 m0, s65, 3072
    s_add_u32 s81, s81, 8192
    buffer_load_dwordx4 v1, s[36:39], s81 offen lds
    v_mfma_f32_32x32x16_bf16 v[56:71], v[160:163], v[156:159], v[56:71]
    v_readlane_b32 s80, v249, 5
    s_add_u32 m0, s65, 4096
    s_bitcmp1_b32 s80, 0
    s_cselect_b32 s36, s8, s16
    s_cselect_b32 s37, s9, s17
    s_and_b32 s81, s80, -2
    buffer_load_dwordx4 v1, s[36:39], s81 offen lds
    s_add_u32 m0, s65, 5120
    s_add_u32 s81, s81, 8192
    buffer_load_dwordx4 v1, s[36:39], s81 offen lds
    v_mfma_f32_32x32x16_bf16 v[88:103], v[164:167], v[156:159], v[88:103]
    s_waitcnt lgkmcnt(6)
    v_mfma_f32_32x32x16_bf16 v[40:55], v[112:115], v[104:107], v[40:55]
    ds_read_b64_tr_b16 v[144:145], v25 offset:53248
    ds_read_b64_tr_b16 v[146:147], v25 offset:53760
    ds_read_b128 v[136:139], v23 offset:49152
    v_mfma_f32_32x32x16_bf16 v[72:87], v[116:119], v[104:107], v[72:87]
    ds_read_b64_tr_b16 v[148:149], v26 offset:53248
    ds_read_b64_tr_b16 v[150:151], v26 offset:53760
    ds_read_b128 v[140:143], v23 offset:53248
    v_mfma_f32_32x32x16_bf16 v[56:71], v[112:115], v[108:111], v[56:71]
    v_mfma_f32_32x32x16_bf16 v[88:103], v[116:119], v[108:111], v[88:103]
    s_waitcnt lgkmcnt(6)
    v_mfma_f32_32x32x16_bf16 v[40:55], v[128:131], v[120:123], v[40:55]
    ds_read_b64_tr_b16 v[160:161], v25 offset:55296
    ds_read_b64_tr_b16 v[162:163], v25 offset:55808
    ds_read_b128 v[152:155], v24 offset:49152
    v_mfma_f32_32x32x16_bf16 v[72:87], v[132:135], v[120:123], v[72:87]
    ds_read_b64_tr_b16 v[164:165], v26 offset:55296
    ds_read_b64_tr_b16 v[166:167], v26 offset:55808
    ds_read_b128 v[156:159], v24 offset:53248
    v_mfma_f32_32x32x16_bf16 v[56:71], v[128:131], v[124:127], v[56:71]
    v_mfma_f32_32x32x16_bf16 v[88:103], v[132:135], v[124:127], v[88:103]
    s_waitcnt lgkmcnt(6)
    v_mfma_f32_32x32x16_bf16 v[40:55], v[144:147], v[136:139], v[40:55]
    s_waitcnt lgkmcnt(0)
    s_barrier
    v_mfma_f32_32x32x16_bf16 v[72:87], v[148:151], v[136:139], v[72:87]
    v_readlane_b32 s80, v249, 6
    s_add_u32 m0, s65, 49152
    s_bitcmp1_b32 s80, 0
    s_cselect_b32 s36, s8, s16
    s_cselect_b32 s37, s9, s17
    s_and_b32 s81, s80, -2
    buffer_load_dwordx4 v1, s[36:39], s81 offen lds
    v_mfma_f32_32x32x16_bf16 v[56:71], v[144:147], v[140:143], v[56:71]
    s_add_u32 m0, s65, 50176
    s_add_u32 s81, s81, 8192
    buffer_load_dwordx4 v1, s[36:39], s81 offen lds
    v_readlane_b32 s80, v249, 7
    s_add_u32 m0, s65, 51200
    s_bitcmp1_b32 s80, 0
    s_cselect_b32 s36, s8, s16
    s_cselect_b32 s37, s9, s17
    s_and_b32 s81, s80, -2
    buffer_load_dwordx4 v1, s[36:39], s81 offen lds
    v_mfma_f32_32x32x16_bf16 v[88:103], v[148:151], v[140:143], v[88:103]
    s_waitcnt lgkmcnt(0)
    v_mfma_f32_32x32x16_bf16 v[40:55], v[160:163], v[152:155], v[40:55]
    v_mfma_f32_32x32x16_bf16 v[72:87], v[164:167], v[152:155], v[72:87]
    s_add_u32 m0, s65, 52224
    s_add_u32 s81, s81, 8192
    buffer_load_dwordx4 v1, s[36:39], s81 offen lds
    v_mfma_f32_32x32x16_bf16 v[56:71], v[160:163], v[156:159], v[56:71]
    v_readlane_b32 s80, v249, 8
    s_add_u32 m0, s65, 53248
    s_bitcmp1_b32 s80, 0
    s_cselect_b32 s36, s8, s16
    s_cselect_b32 s37, s9, s17
    s_and_b32 s81, s80, -2
    buffer_load_dwordx4 v1, s[36:39], s81 offen lds
    s_add_u32 m0, s65, 54272
    s_add_u32 s81, s81, 8192
    buffer_load_dwordx4 v1, s[36:39], s81 offen lds
    v_mfma_f32_32x32x16_bf16 v[88:103], v[164:167], v[156:159], v[88:103]
    v_mov_b32 v8, 0xbdd2d3e8
    v_mov_b32 v9, 0xbdd2d3e8
    v_mov_b32 v10, 0xc0135761
    v_mov_b32 v11, 0xc0135761
    s_cmp_ge_u32 s3, 4
    s_cbranch_scc1 L_f_g1
    s_setprio 2
    s_waitcnt vmcnt(12)
L_sw_2:
    ds_read_b64_tr_b16 v[104:105], v4 offset:32768
    ds_read_b64_tr_b16 v[106:107], v4 offset:33280
    ds_read_b64_tr_b16 v[108:109], v5 offset:32768
    ds_read_b64_tr_b16 v[110:111], v5 offset:33280
    ds_read_b64_tr_b16 v[112:113], v4 offset:34816
    ds_read_b64_tr_b16 v[114:115], v4 offset:35328
    ds_read_b64_tr_b16 v[116:117], v5 offset:34816
    ds_read_b64_tr_b16 v[118:119], v5 offset:35328
    ds_read_b64_tr_b16 v[120:121], v4 offset:36864
    ds_read_b64_tr_b16 v[122:123], v4 offset:37376
    ds_read_b64_tr_b16 v[124:125], v5 offset:36864
    ds_read_b64_tr_b16 v[126:127], v5 offset:37376
L_sw_1:
    s_nop 4
    v_pk_mul_f32 v[12:13], v[40:41], v[40:41]
    v_pk_mul_f32 v[14:15], v[42:43], v[42:43]
    v_pk_mul_f32 v[16:17], v[44:45], v[44:45]
    v_pk_mul_f32 v[18:19], v[46:47], v[46:47]
    v_pk_fma_f32 v[12:13], v[12:13], v[8:9], v[10:11]
    v_pk_fma_f32 v[14:15], v[14:15], v[8:9], v[10:11]
    v_pk_fma_f32 v[16:17], v[16:17], v[8:9], v[10:11]
    v_pk_fma_f32 v[18:19], v[18:19], v[8:9], v[10:11]
    v_pk_mul_f32 v[12:13], v[12:13], v[40:41]
    v_pk_mul_f32 v[14:15], v[14:15], v[42:43]
    v_pk_mul_f32 v[16:17], v[16:17], v[44:45]
    v_pk_mul_f32 v[18:19], v[18:19], v[46:47]
    v_exp_f32 v12, v12
    v_exp_f32 v13, v13
    v_exp_f32 v14, v14
    v_exp_f32 v15, v15
    v_exp_f32 v16, v16
    v_exp_f32 v17, v17
    v_exp_f32 v18, v18
    v_exp_f32 v19, v19
    v_pk_add_f32 v[12:13], v[12:13], 1.0 op_sel_hi:[1,0]
    v_pk_add_f32 v[14:15], v[14:15], 1.0 op_sel_hi:[1,0]
    v_pk_add_f32 v[16:17], v[16:17], 1.0 op_sel_hi:[1,0]
    v_pk_add_f32 v[18:19], v[18:19], 1.0 op_sel_hi:[1,0]
    v_rcp_f32 v12, v12
    v_rcp_f32 v13, v13
    v_rcp_f32 v14, v14
    v_rcp_f32 v15, v15
    v_rcp_f32 v16, v16
    v_rcp_f32 v17, v17
    v_rcp_f32 v18, v18
    v_rcp_f32 v19, v19
    v_pk_mul_f32 v[12:13], v[12:13], v[40:41]
    v_pk_mul_f32 v[14:15], v[14:15], v[42:43]
    v_pk_mul_f32 v[16:17], v[16:17], v[44:45]
    v_pk_mul_f32 v[18:19], v[18:19], v[46:47]
    v_cvt_pk_bf16_f32 v20, v12, v13
    v_cvt_pk_bf16_f32 v21, v14, v15
    v_cvt_pk_bf16_f32 v22, v16, v17
    v_cvt_pk_bf16_f32 v23, v18, v19
    buffer_store_dwordx4 v[20:23], v6, s[40:43], 0 offen offset:0 sc1
    s_waitcnt lgkmcnt(0)
    v_readlane_b32 s80, v249, 9
    s_add_u32 m0, s65, 98304
    s_bitcmp1_b32 s80, 0
    s_cselect_b32 s36, s8, s16
    s_cselect_b32 s37, s9, s17
    s_and_b32 s81, s80, -2
    buffer_load_dwordx4 v1, s[36:39], s81 offen lds
    s_add_u32 m0, s65, 99328
    s_add_u32 s81, s81, 8192
    buffer_load_dwordx4 v1, s[36:39], s81 offen lds
    v_readlane_b32 s80, v249, 10
    s_add_u32 m0, s65, 100352
    s_bitcmp1_b32 s80, 0
    s_cselect_b32 s36, s8, s16
    s_cselect_b32 s37, s9, s17
    s_and_b32 s81, s80, -2
    buffer_load_dwordx4 v1, s[36:39], s81 offen lds
    s_waitcnt vmcnt(10)
L_sw_4:
    ds_read_b64_tr_b16 v[128:129], v2 offset:0
    ds_read_b64_tr_b16 v[130:131], v2 offset:512
    ds_read_b64_tr_b16 v[132:133], v3 offset:0
    ds_read_b64_tr_b16 v[134:135], v3 offset:512
    ds_read_b64_tr_b16 v[136:137], v2 offset:2048
    ds_read_b64_tr_b16 v[138:139], v2 offset:2560
    ds_read_b64_tr_b16 v[140:141], v3 offset:2048
    ds_read_b64_tr_b16 v[142:143], v3 offset:2560
    ds_read_b64_tr_b16 v[144:145], v2 offset:4096
    ds_read_b64_tr_b16 v[146:147], v2 offset:4608
    ds_read_b64_tr_b16 v[148:149], v3 offset:4096
    ds_read_b64_tr_b16 v[150:151], v3 offset:4608
L_sw_3:
    v_pk_mul_f32 v[12:13], v[48:49], v[48:49]
    v_pk_mul_f32 v[14:15], v[50:51], v[50:51]
    v_pk_mul_f32 v[16:17], v[52:53], v[52:53]
    v_pk_mul_f32 v[18:19], v[54:55], v[54:55]
    v_pk_fma_f32 v[12:13], v[12:13], v[8:9], v[10:11]
    v_pk_fma_f32 v[14:15], v[14:15], v[8:9], v[10:11]
    v_pk_fma_f32 v[16:17], v[16:17], v[8:9], v[10:11]
    v_pk_fma_f32 v[18:19], v[18:19], v[8:9], v[10:11]
    v_pk_mul_f32 v[12:13], v[12:13], v[48:49]
    v_pk_mul_f32 v[14:15], v[14:15], v[50:51]
    v_pk_mul_f32 v[16:17], v[16:17], v[52:53]
    v_pk_mul_f32 v[18:19], v[18:19], v[54:55]
    v_exp_f32 v12, v12
    v_exp_f32 v13, v13
    v_exp_f32 v14, v14
    v_exp_f32 v15, v15
    v_exp_f32 v16, v16
    v_exp_f32 v17, v17
    v_exp_f32 v18, v18
    v_exp_f32 v19, v19
    v_pk_add_f32 v[12:13], v[12:13], 1.0 op_sel_hi:[1,0]
    v_pk_add_f32 v[14:15], v[14:15], 1.0 op_sel_hi:[1,0]
    v_pk_add_f32 v[16:17], v[16:17], 1.0 op_sel_hi:[1,0]
    v_pk_add_f32 v[18:19], v[18:19], 1.0 op_sel_hi:[1,0]
    v_rcp_f32 v12, v12
    v_rcp_f32 v13, v13
    v_rcp_f32 v14, v14
    v_rcp_f32 v15, v15
    v_rcp_f32 v16, v16
    v_rcp_f32 v17, v17
    v_rcp_f32 v18, v18
    v_rcp_f32 v19, v19
    v_pk_mul_f32 v[12:13], v[12:13], v[48:49]
    v_pk_mul_f32 v[14:15], v[14:15], v[50:51]
    v_pk_mul_f32 v[16:17], v[16:17], v[52:53]
    v_pk_mul_f32 v[18:19], v[18:19], v[54:55]
    v_cvt_pk_bf16_f32 v24, v12, v13
    v_cvt_pk_bf16_f32 v25, v14, v15
    v_cvt_pk_bf16_f32 v26, v16, v17
    v_cvt_pk_bf16_f32 v27, v18, v19
    buffer_store_dwordx4 v[24:27], v6, s[40:43], 0 offen offset:1024 sc1
    s_waitcnt lgkmcnt(0)
    s_add_u32 m0, s65, 101376
    s_add_u32 s81, s81, 8192
    buffer_load_dwordx4 v1, s[36:39], s81 offen lds
    v_readlane_b32 s80, v249, 11
    s_add_u32 m0, s65, 102400
    s_bitcmp1_b32 s80, 0
    s_cselect_b32 s36, s8, s16
    s_cselect_b32 s37, s9, s17
    s_and_b32 s81, s80, -2
    buffer_load_dwordx4 v1, s[36:39], s81 offen lds
    s_add_u32 m0, s65, 103424
    s_add_u32 s81, s81, 8192
    buffer_load_dwordx4 v1, s[36:39], s81 offen lds
    v_pk_mul_f32 v[12:13], v[72:73], v[72:73]
    v_pk_mul_f32 v[14:15], v[74:75], v[74:75]
    v_pk_mul_f32 v[16:17], v[76:77], v[76:77]
    v_pk_mul_f32 v[18:19], v[78:79], v[78:79]
    v_pk_fma_f32 v[12:13], v[12:13], v[8:9], v[10:11]
    v_pk_fma_f32 v[14:15], v[14:15], v[8:9], v[10:11]
    v_pk_fma_f32 v[16:17], v[16:17], v[8:9], v[10:11]
    v_pk_fma_f32 v[18:19], v[18:19], v[8:9], v[10:11]
    v_pk_mul_f32 v[12:13], v[12:13], v[72:73]
    v_pk_mul_f32 v[14:15], v[14:15], v[74:75]
    v_pk_mul_f32 v[16:17], v[16:17], v[76:77]
    v_pk_mul_f32 v[18:19], v[18:19], v[78:79]
    v_exp_f32 v12, v12
    v_exp_f32 v13, v13
    v_exp_f32 v14, v14
    v_exp_f32 v15, v15
    v_exp_f32 v16, v16
    v_exp_f32 v17, v17
    v_exp_f32 v18, v18
    v_exp_f32 v19, v19
    v_pk_add_f32 v[12:13], v[12:13], 1.0 op_sel_hi:[1,0]
    v_pk_add_f32 v[14:15], v[14:15], 1.0 op_sel_hi:[1,0]
    v_pk_add_f32 v[16:17], v[16:17], 1.0 op_sel_hi:[1,0]
    v_pk_add_f32 v[18:19], v[18:19], 1.0 op_sel_hi:[1,0]
    v_rcp_f32 v12, v12
    v_rcp_f32 v13, v13
    v_rcp_f32 v14, v14
    v_rcp_f32 v15, v15
    v_rcp_f32 v16, v16
    v_rcp_f32 v17, v17
    v_rcp_f32 v18, v18
    v_rcp_f32 v19, v19
    v_pk_mul_f32 v[12:13], v[12:13], v[72:73]
    v_pk_mul_f32 v[14:15], v[14:15], v[74:75]
    v_pk_mul_f32 v[16:17], v[16:17], v[76:77]
    v_pk_mul_f32 v[18:19], v[18:19], v[78:79]
    v_cvt_pk_bf16_f32 v28, v12, v13
    v_cvt_pk_bf16_f32 v29, v14, v15
    v_cvt_pk_bf16_f32 v30, v16, v17
    v_cvt_pk_bf16_f32 v31, v18, v19
    buffer_store_dwordx4 v[28:31], v6, s[40:43], 0 offen offset:2048 sc1
    v_readlane_b32 s80, v249, 12
    s_add_u32 m0, s65, 0
    s_bitcmp1_b32 s80, 0
    s_cselect_b32 s36, s8, s16
    s_cselect_b32 s37, s9, s17
    s_and_b32 s81, s80, -2
    buffer_load_dwordx4 v1, s[36:39], s81 offen lds
    s_add_u32 m0, s65, 1024
    s_add_u32 s81, s81, 8192
    buffer_load_dwordx4 v1, s[36:39], s81 offen lds
    v_readlane_b32 s80, v249, 13
    s_add_u32 m0, s65, 2048
    s_bitcmp1_b32 s80, 0
    s_cselect_b32 s36, s8, s16
    s_cselect_b32 s37, s9, s17
    s_and_b32 s81, s80, -2
    buffer_load_dwordx4 v1, s[36:39], s81 offen lds
    s_waitcnt vmcnt(12)
L_sw_6:
    ds_read_b64_tr_b16 v[152:153], v2 offset:49152
    ds_read_b64_tr_b16 v[154:155], v2 offset:49664
    ds_read_b64_tr_b16 v[156:157], v3 offset:49152
    ds_read_b64_tr_b16 v[158:159], v3 offset:49664
    ds_read_b64_tr_b16 v[160:161], v2 offset:51200
    ds_read_b64_tr_b16 v[162:163], v2 offset:51712
    ds_read_b64_tr_b16 v[164:165], v3 offset:51200
    ds_read_b64_tr_b16 v[166:167], v3 offset:51712
    ds_read_b64_tr_b16 v[168:169], v2 offset:53248
    ds_read_b64_tr_b16 v[170:171], v2 offset:53760
    ds_read_b64_tr_b16 v[172:173], v3 offset:53248
    ds_read_b64_tr_b16 v[174:175], v3 offset:53760
L_sw_5:
    v_pk_mul_f32 v[12:13], v[80:81], v[80:81]
    v_pk_mul_f32 v[14:15], v[82:83], v[82:83]
    v_pk_mul_f32 v[16:17], v[84:85], v[84:85]
    v_pk_mul_f32 v[18:19], v[86:87], v[86:87]
    v_pk_fma_f32 v[12:13], v[12:13], v[8:9], v[10:11]
    v_pk_fma_f32 v[14:15], v[14:15], v[8:9], v[10:11]
    v_pk_fma_f32 v[16:17], v[16:17], v[8:9], v[10:11]
    v_pk_fma_f32 v[18:19], v[18:19], v[8:9], v[10:11]
    v_pk_mul_f32 v[12:13], v[12:13], v[80:81]
    v_pk_mul_f32 v[14:15], v[14:15], v[82:83]
    v_pk_mul_f32 v[16:17], v[16:17], v[84:85]
    v_pk_mul_f32 v[18:19], v[18:19], v[86:87]
    v_exp_f32 v12, v12
    v_exp_f32 v13, v13
    v_exp_f32 v14, v14
    v_exp_f32 v15, v15
    v_exp_f32 v16, v16
    v_exp_f32 v17, v17
    v_exp_f32 v18, v18
    v_exp_f32 v19, v19
    v_pk_add_f32 v[12:13], v[12:13], 1.0 op_sel_hi:[1,0]
    v_pk_add_f32 v[14:15], v[14:15], 1.0 op_sel_hi:[1,0]
    v_pk_add_f32 v[16:17], v[16:17], 1.0 op_sel_hi:[1,0]
    v_pk_add_f32 v[18:19], v[18:19], 1.0 op_sel_hi:[1,0]
    v_rcp_f32 v12, v12
    v_rcp_f32 v13, v13
    v_rcp_f32 v14, v14
    v_rcp_f32 v15, v15
    v_rcp_f32 v16, v16
    v_rcp_f32 v17, v17
    v_rcp_f32 v18, v18
    v_rcp_f32 v19, v19
    v_pk_mul_f32 v[12:13], v[12:13], v[80:81]
    v_pk_mul_f32 v[14:15], v[14:15], v[82:83]
    v_pk_mul_f32 v[16:17], v[16:17], v[84:85]
    v_pk_mul_f32 v[18:19], v[18:19], v[86:87]
    v_cvt_pk_bf16_f32 v32, v12, v13
    v_cvt_pk_bf16_f32 v33, v14, v15
    v_cvt_pk_bf16_f32 v34, v16, v17
    v_cvt_pk_bf16_f32 v35, v18, v19
    buffer_store_dwordx4 v[32:35], v6, s[40:43], 0 offen offset:3072 sc1
    s_waitcnt lgkmcnt(0)
    s_add_u32 m0, s65, 3072
    s_add_u32 s81, s81, 8192
    buffer_load_dwordx4 v1, s[36:39], s81 offen lds
    v_readlane_b32 s80, v249, 14
    s_add_u32 m0, s65, 4096
    s_bitcmp1_b32 s80, 0
    s_cselect_b32 s36, s8, s16
    s_cselect_b32 s37, s9, s17
    s_and_b32 s81, s80, -2
    buffer_load_dwordx4 v1, s[36:39], s81 offen lds
    s_add_u32 m0, s65, 5120
    s_add_u32 s81, s81, 8192
    buffer_load_dwordx4 v1, s[36:39], s81 offen lds
    v_pk_mul_f32 v[12:13], v[56:57], v[56:57]
    v_pk_mul_f32 v[14:15], v[58:59], v[58:59]
    v_pk_mul_f32 v[16:17], v[60:61], v[60:61]
    v_pk_mul_f32 v[18:19], v[62:63], v[62:63]
    v_pk_fma_f32 v[12:13], v[12:13], v[8:9], v[10:11]
    v_pk_fma_f32 v[14:15], v[14:15], v[8:9], v[10:11]
    v_pk_fma_f32 v[16:17], v[16:17], v[8:9], v[10:11]
    v_pk_fma_f32 v[18:19], v[18:19], v[8:9], v[10:11]
    v_pk_mul_f32 v[12:13], v[12:13], v[56:57]
    v_pk_mul_f32 v[14:15], v[14:15], v[58:59]
    v_pk_mul_f32 v[16:17], v[16:17], v[60:61]
    v_pk_mul_f32 v[18:19], v[18:19], v[62:63]
    v_exp_f32 v12, v12
    v_exp_f32 v13, v13
    v_exp_f32 v14, v14
    v_exp_f32 v15, v15
    v_exp_f32 v16, v16
    v_exp_f32 v17, v17
    v_exp_f32 v18, v18
    v_exp_f32 v19, v19
    v_pk_add_f32 v[12:13], v[12:13], 1.0 op_sel_hi:[1,0]
    v_pk_add_f32 v[14:15], v[14:15], 1.0 op_sel_hi:[1,0]
    v_pk_add_f32 v[16:17], v[16:17], 1.0 op_sel_hi:[1,0]
    v_pk_add_f32 v[18:19], v[18:19], 1.0 op_sel_hi:[1,0]
    v_rcp_f32 v12, v12
    v_rcp_f32 v13, v13
    v_rcp_f32 v14, v14
    v_rcp_f32 v15, v15
    v_rcp_f32 v16, v16
    v_rcp_f32 v17, v17
    v_rcp_f32 v18, v18
    v_rcp_f32 v19, v19
    v_pk_mul_f32 v[12:13], v[12:13], v[56:57]
    v_pk_mul_f32 v[14:15], v[14:15], v[58:59]
    v_pk_mul_f32 v[16:17], v[16:17], v[60:61]
    v_pk_mul_f32 v[18:19], v[18:19], v[62:63]
    v_cvt_pk_bf16_f32 v20, v12, v13
    v_cvt_pk_bf16_f32 v21, v14, v15
    v_cvt_pk_bf16_f32 v22, v16, v17
    v_cvt_pk_bf16_f32 v23, v18, v19
    buffer_store_dwordx4 v[20:23], v6, s[40:43], s73 offen offset:0 sc1
    v_readlane_b32 s80, v249, 15
    s_add_u32 m0, s65, 49152
    s_bitcmp1_b32 s80, 0
    s_cselect_b32 s36, s8, s16
    s_cselect_b32 s37, s9, s17
    s_and_b32 s81, s80, -2
    buffer_load_dwordx4 v1, s[36:39], s81 offen lds
    s_add_u32 m0, s65, 50176
    s_add_u32 s81, s81, 8192
    buffer_load_dwordx4 v1, s[36:39], s81 offen lds
    v_readlane_b32 s80, v249, 16
    s_add_u32 m0, s65, 51200
    s_bitcmp1_b32 s80, 0
    s_cselect_b32 s36, s8, s16
    s_cselect_b32 s37, s9, s17
    s_and_b32 s81, s80, -2
    buffer_load_dwordx4 v1, s[36:39], s81 offen lds
    v_pk_mul_f32 v[12:13], v[64:65], v[64:65]
    v_pk_mul_f32 v[14:15], v[66:67], v[66:67]
    v_pk_mul_f32 v[16:17], v[68:69], v[68:69]
    v_pk_mul_f32 v[18:19], v[70:71], v[70:71]
    v_pk_fma_f32 v[12:13], v[12:13], v[8:9], v[10:11]
    v_pk_fma_f32 v[14:15], v[14:15], v[8:9], v[10:11]
    v_pk_fma_f32 v[16:17], v[16:17], v[8:9], v[10:11]
    v_pk_fma_f32 v[18:19], v[18:19], v[8:9], v[10:11]
    v_pk_mul_f32 v[12:13], v[12:13], v[64:65]
    v_pk_mul_f32 v[14:15], v[14:15], v[66:67]
    v_pk_mul_f32 v[16:17], v[16:17], v[68:69]
    v_pk_mul_f32 v[18:19], v[18:19], v[70:71]
    v_exp_f32 v12, v12
    v_exp_f32 v13, v13
    v_exp_f32 v14, v14
    v_exp_f32 v15, v15
    v_exp_f32 v16, v16
    v_exp_f32 v17, v17
    v_exp_f32 v18, v18
    v_exp_f32 v19, v19
    v_pk_add_f32 v[12:13], v[12:13], 1.0 op_sel_hi:[1,0]
    v_pk_add_f32 v[14:15], v[14:15], 1.0 op_sel_hi:[1,0]
    v_pk_add_f32 v[16:17], v[16:17], 1.0 op_sel_hi:[1,0]
    v_pk_add_f32 v[18:19], v[18:19], 1.0 op_sel_hi:[1,0]
    v_rcp_f32 v12, v12
    v_rcp_f32 v13, v13
    v_rcp_f32 v14, v14
    v_rcp_f32 v15, v15
    v_rcp_f32 v16, v16
    v_rcp_f32 v17, v17
    v_rcp_f32 v18, v18
    v_rcp_f32 v19, v19
    v_pk_mul_f32 v[12:13], v[12:13], v[64:65]
    v_pk_mul_f32 v[14:15], v[14:15], v[66:67]
    v_pk_mul_f32 v[16:17], v[16:17], v[68:69]
    v_pk_mul_f32 v[18:19], v[18:19], v[70:71]
    v_cvt_pk_bf16_f32 v24, v12, v13
    v_cvt_pk_bf16_f32 v25, v14, v15
    v_cvt_pk_bf16_f32 v26, v16, v17
    v_cvt_pk_bf16_f32 v27, v18, v19
    buffer_store_dwordx4 v[24:27], v6, s[40:43], s73 offen offset:1024 sc1
    s_add_u32 m0, s65, 52224
    s_add_u32 s81, s81, 8192
    buffer_load_dwordx4 v1, s[36:39], s81 offen lds
    v_readlane_b32 s80, v249, 17
    s_add_u32 m0, s65, 53248
    s_bitcmp1_b32 s80, 0
    s_cselect_b32 s36, s8, s16
    s_cselect_b32 s37, s9, s17
    s_and_b32 s81, s80, -2
    buffer_load_dwordx4 v1, s[36:39], s81 offen lds
    s_add_u32 m0, s65, 54272
    s_add_u32 s81, s81, 8192
    buffer_load_dwordx4 v1, s[36:39], s81 offen lds
    v_pk_mul_f32 v[12:13], v[88:89], v[88:89]
    v_pk_mul_f32 v[14:15], v[90:91], v[90:91]
    v_pk_mul_f32 v[16:17], v[92:93], v[92:93]
    v_pk_mul_f32 v[18:19], v[94:95], v[94:95]
    v_pk_fma_f32 v[12:13], v[12:13], v[8:9], v[10:11]
    v_pk_fma_f32 v[14:15], v[14:15], v[8:9], v[10:11]
    v_pk_fma_f32 v[16:17], v[16:17], v[8:9], v[10:11]
    v_pk_fma_f32 v[18:19], v[18:19], v[8:9], v[10:11]
    v_pk_mul_f32 v[12:13], v[12:13], v[88:89]
    v_pk_mul_f32 v[14:15], v[14:15], v[90:91]
    v_pk_mul_f32 v[16:17], v[16:17], v[92:93]
    v_pk_mul_f32 v[18:19], v[18:19], v[94:95]
    v_exp_f32 v12, v12
    v_exp_f32 v13, v13
    v_exp_f32 v14, v14
    v_exp_f32 v15, v15
    v_exp_f32 v16, v16
    v_exp_f32 v17, v17
    v_exp_f32 v18, v18
    v_exp_f32 v19, v19
    v_pk_add_f32 v[12:13], v[12:13], 1.0 op_sel_hi:[1,0]
    v_pk_add_f32 v[14:15], v[14:15], 1.0 op_sel_hi:[1,0]
    v_pk_add_f32 v[16:17], v[16:17], 1.0 op_sel_hi:[1,0]
    v_pk_add_f32 v[18:19], v[18:19], 1.0 op_sel_hi:[1,0]
    v_rcp_f32 v12, v12
    v_rcp_f32 v13, v13
    v_rcp_f32 v14, v14
    v_rcp_f32 v15, v15
    v_rcp_f32 v16, v16
    v_rcp_f32 v17, v17
    v_rcp_f32 v18, v18
    v_rcp_f32 v19, v19
    v_pk_mul_f32 v[12:13], v[12:13], v[88:89]
    v_pk_mul_f32 v[14:15], v[14:15], v[90:91]
    v_pk_mul_f32 v[16:17], v[16:17], v[92:93]
    v_pk_mul_f32 v[18:19], v[18:19], v[94:95]
    v_cvt_pk_bf16_f32 v28, v12, v13
    v_cvt_pk_bf16_f32 v29, v14, v15
    v_cvt_pk_bf16_f32 v30, v16, v17
    v_cvt_pk_bf16_f32 v31, v18, v19
    buffer_store_dwordx4 v[28:31], v6, s[40:43], s73 offen offset:2048 sc1
    v_pk_mul_f32 v[12:13], v[96:97], v[96:97]
    v_pk_mul_f32 v[14:15], v[98:99], v[98:99]
    v_pk_mul_f32 v[16:17], v[100:101], v[100:101]
    v_pk_mul_f32 v[18:19], v[102:103], v[102:103]
    v_pk_fma_f32 v[12:13], v[12:13], v[8:9], v[10:11]
    v_pk_fma_f32 v[14:15], v[14:15], v[8:9], v[10:11]
    v_pk_fma_f32 v[16:17], v[16:17], v[8:9], v[10:11]
    v_pk_fma_f32 v[18:19], v[18:19], v[8:9], v[10:11]
    v_pk_mul_f32 v[12:13], v[12:13], v[96:97]
    v_pk_mul_f32 v[14:15], v[14:15], v[98:99]
    v_pk_mul_f32 v[16:17], v[16:17], v[100:101]
    v_pk_mul_f32 v[18:19], v[18:19], v[102:103]
    v_exp_f32 v12, v12
    v_exp_f32 v13, v13
    v_exp_f32 v14, v14
    v_exp_f32 v15, v15
    v_exp_f32 v16, v16
    v_exp_f32 v17, v17
    v_exp_f32 v18, v18
    v_exp_f32 v19, v19
    v_pk_add_f32 v[12:13], v[12:13], 1.0 op_sel_hi:[1,0]
    v_pk_add_f32 v[14:15], v[14:15], 1.0 op_sel_hi:[1,0]
    v_pk_add_f32 v[16:17], v[16:17], 1.0 op_sel_hi:[1,0]
    v_pk_add_f32 v[18:19], v[18:19], 1.0 op_sel_hi:[1,0]
    v_rcp_f32 v12, v12
    v_rcp_f32 v13, v13
    v_rcp_f32 v14, v14
    v_rcp_f32 v15, v15
    v_rcp_f32 v16, v16
    v_rcp_f32 v17, v17
    v_rcp_f32 v18, v18
    v_rcp_f32 v19, v19
    v_pk_mul_f32 v[12:13], v[12:13], v[96:97]
    v_pk_mul_f32 v[14:15], v[14:15], v[98:99]
    v_pk_mul_f32 v[16:17], v[16:17], v[100:101]
    v_pk_mul_f32 v[18:19], v[18:19], v[102:103]
    v_cvt_pk_bf16_f32 v32, v12, v13
    v_cvt_pk_bf16_f32 v33, v14, v15
    v_cvt_pk_bf16_f32 v34, v16, v17
    v_cvt_pk_bf16_f32 v35, v18, v19
    buffer_store_dwordx4 v[32:35], v6, s[40:43], s73 offen offset:3072 sc1
    v_mov_b32 v7, 1
    s_waitcnt vmcnt(0)
    s_mov_b64 exec, 1
    buffer_store_dword v7, off, s[40:43], s71 sc1
    s_mov_b64 exec, -1
    s_branch L_p2_g0
L_f_g1:
    s_setprio 1
    s_waitcnt vmcnt(12)
L_sw_8:
    ds_read_b64_tr_b16 v[104:105], v4 offset:32768
    ds_read_b64_tr_b16 v[106:107], v4 offset:33280
    ds_read_b64_tr_b16 v[108:109], v5 offset:32768
    ds_read_b64_tr_b16 v[110:111], v5 offset:33280
    ds_read_b64_tr_b16 v[112:113], v4 offset:34816
    ds_read_b64_tr_b16 v[114:115], v4 offset:35328
    ds_read_b64_tr_b16 v[116:117], v5 offset:34816
    ds_read_b64_tr_b16 v[118:119], v5 offset:35328
    ds_read_b64_tr_b16 v[120:121], v4 offset:36864
    ds_read_b64_tr_b16 v[122:123], v4 offset:37376
    ds_read_b64_tr_b16 v[124:125], v5 offset:36864
    ds_read_b64_tr_b16 v[126:127], v5 offset:37376
L_sw_7:
    s_waitcnt lgkmcnt(0)
    v_readlane_b32 s80, v249, 9
    s_add_u32 m0, s65, 98304
    s_bitcmp1_b32 s80, 0
    s_cselect_b32 s36, s8, s16
    s_cselect_b32 s37, s9, s17
    s_and_b32 s81, s80, -2
    buffer_load_dwordx4 v1, s[36:39], s81 offen lds
    s_add_u32 m0, s65, 99328
    s_add_u32 s81, s81, 8192
    buffer_load_dwordx4 v1, s[36:39], s81 offen lds
    v_readlane_b32 s80, v249, 10
    s_add_u32 m0, s65, 100352
    s_bitcmp1_b32 s80, 0
    s_cselect_b32 s36, s8, s16
    s_cselect_b32 s37, s9, s17
    s_and_b32 s81, s80, -2
    buffer_load_dwordx4 v1, s[36:39], s81 offen lds
    s_add_u32 m0, s65, 101376
    s_add_u32 s81, s81, 8192
    buffer_load_dwordx4 v1, s[36:39], s81 offen lds
    v_readlane_b32 s80, v249, 11
    s_add_u32 m0, s65, 102400
    s_bitcmp1_b32 s80, 0
    s_cselect_b32 s36, s8, s16
    s_cselect_b32 s37, s9, s17
    s_and_b32 s81, s80, -2
    buffer_load_dwordx4 v1, s[36:39], s81 offen lds
    s_add_u32 m0, s65, 103424
    s_add_u32 s81, s81, 8192
    buffer_load_dwordx4 v1, s[36:39], s81 offen lds
    s_waitcnt vmcnt(12)
L_sw_10:
    ds_read_b64_tr_b16 v[128:129], v2 offset:0
    ds_read_b64_tr_b16 v[130:131], v2 offset:512
    ds_read_b64_tr_b16 v[132:133], v3 offset:0
    ds_read_b64_tr_b16 v[134:135], v3 offset:512
    ds_read_b64_tr_b16 v[136:137], v2 offset:2048
    ds_read_b64_tr_b16 v[138:139], v2 offset:2560
    ds_read_b64_tr_b16 v[140:141], v3 offset:2048
    ds_read_b64_tr_b16 v[142:143], v3 offset:2560
    ds_read_b64_tr_b16 v[144:145], v2 offset:4096
    ds_read_b64_tr_b16 v[146:147], v2 offset:4608
    ds_read_b64_tr_b16 v[148:149], v3 offset:4096
    ds_read_b64_tr_b16 v[150:151], v3 offset:4608
L_sw_9:
    s_waitcnt lgkmcnt(0)
    v_readlane_b32 s80, v249, 12
    s_add_u32 m0, s65, 0
    s_bitcmp1_b32 s80, 0
    s_cselect_b32 s36, s8, s16
    s_cselect_b32 s37, s9, s17
    s_and_b32 s81, s80, -2
    buffer_load_dwordx4 v1, s[36:39], s81 offen lds
    s_add_u32 m0, s65, 1024
    s_add_u32 s81, s81, 8192
    buffer_load_dwordx4 v1, s[36:39], s81 offen lds
    v_readlane_b32 s80, v249, 13
    s_add_u32 m0, s65, 2048
    s_bitcmp1_b32 s80, 0
    s_cselect_b32 s36, s8, s16
    s_cselect_b32 s37, s9, s17
    s_and_b32 s81, s80, -2
    buffer_load_dwordx4 v1, s[36:39], s81 offen lds
    s_add_u32 m0, s65, 3072
    s_add_u32 s81, s81, 8192
    buffer_load_dwordx4 v1, s[36:39], s81 offen lds
    v_readlane_b32 s80, v249, 14
    s_add_u32 m0, s65, 4096
    s_bitcmp1_b32 s80, 0
    s_cselect_b32 s36, s8, s16
    s_cselect_b32 s37, s9, s17
    s_and_b32 s81, s80, -2
    buffer_load_dwordx4 v1, s[36:39], s81 offen lds
    s_add_u32 m0, s65, 5120
    s_add_u32 s81, s81, 8192
    buffer_load_dwordx4 v1, s[36:39], s81 offen lds
    s_waitcnt vmcnt(12)
L_sw_12:
    ds_read_b64_tr_b16 v[152:153], v2 offset:49152
    ds_read_b64_tr_b16 v[154:155], v2 offset:49664
    ds_read_b64_tr_b16 v[156:157], v3 offset:49152
    ds_read_b64_tr_b16 v[158:159], v3 offset:49664
    ds_read_b64_tr_b16 v[160:161], v2 offset:51200
    ds_read_b64_tr_b16 v[162:163], v2 offset:51712
    ds_read_b64_tr_b16 v[164:165], v3 offset:51200
    ds_read_b64_tr_b16 v[166:167], v3 offset:51712
    ds_read_b64_tr_b16 v[168:169], v2 offset:53248
    ds_read_b64_tr_b16 v[170:171], v2 offset:53760
    ds_read_b64_tr_b16 v[172:173], v3 offset:53248
    ds_read_b64_tr_b16 v[174:175], v3 offset:53760
L_sw_11:
    s_waitcnt lgkmcnt(0)
    v_readlane_b32 s80, v249, 15
    s_add_u32 m0, s65, 49152
    s_bitcmp1_b32 s80, 0
    s_cselect_b32 s36, s8, s16
    s_cselect_b32 s37, s9, s17
    s_and_b32 s81, s80, -2
    buffer_load_dwordx4 v1, s[36:39], s81 offen lds
    s_add_u32 m0, s65, 50176
    s_add_u32 s81, s81, 8192
    buffer_load_dwordx4 v1, s[36:39], s81 offen lds
    v_readlane_b32 s80, v249, 16
    s_add_u32 m0, s65, 51200
    s_bitcmp1_b32 s80, 0
    s_cselect_b32 s36, s8, s16
    s_cselect_b32 s37, s9, s17
    s_and_b32 s81, s80, -2
    buffer_load_dwordx4 v1, s[36:39], s81 offen lds
    s_add_u32 m0, s65, 52224
    s_add_u32 s81, s81, 8192
    buffer_load_dwordx4 v1, s[36:39], s81 offen lds
    v_readlane_b32 s80, v249, 17
    s_add_u32 m0, s65, 53248
    s_bitcmp1_b32 s80, 0
    s_cselect_b32 s36, s8, s16
    s_cselect_b32 s37, s9, s17
    s_and_b32 s81, s80, -2
    buffer_load_dwordx4 v1, s[36:39], s81 offen lds
    s_add_u32 m0, s65, 54272
    s_add_u32 s81, s81, 8192
    buffer_load_dwordx4 v1, s[36:39], s81 offen lds
    v_pk_mul_f32 v[12:13], v[40:41], v[40:41]
    v_pk_mul_f32 v[14:15], v[42:43], v[42:43]
    v_pk_mul_f32 v[16:17], v[44:45], v[44:45]
    v_pk_mul_f32 v[18:19], v[46:47], v[46:47]
    v_pk_fma_f32 v[12:13], v[12:13], v[8:9], v[10:11]
    v_pk_fma_f32 v[14:15], v[14:15], v[8:9], v[10:11]
    v_pk_fma_f32 v[16:17], v[16:17], v[8:9], v[10:11]
    v_pk_fma_f32 v[18:19], v[18:19], v[8:9], v[10:11]
    v_pk_mul_f32 v[12:13], v[12:13], v[40:41]
    v_pk_mul_f32 v[14:15], v[14:15], v[42:43]
    v_pk_mul_f32 v[16:17], v[16:17], v[44:45]
    v_pk_mul_f32 v[18:19], v[18:19], v[46:47]
    v_exp_f32 v12, v12
    v_exp_f32 v13, v13
    v_exp_f32 v14, v14
    v_exp_f32 v15, v15
    v_exp_f32 v16, v16
    v_exp_f32 v17, v17
    v_exp_f32 v18, v18
    v_exp_f32 v19, v19
    v_pk_add_f32 v[12:13], v[12:13], 1.0 op_sel_hi:[1,0]
    v_pk_add_f32 v[14:15], v[14:15], 1.0 op_sel_hi:[1,0]
    v_pk_add_f32 v[16:17], v[16:17], 1.0 op_sel_hi:[1,0]
    v_pk_add_f32 v[18:19], v[18:19], 1.0 op_sel_hi:[1,0]
    v_rcp_f32 v12, v12
    v_rcp_f32 v13, v13
    v_rcp_f32 v14, v14
    v_rcp_f32 v15, v15
    v_rcp_f32 v16, v16
    v_rcp_f32 v17, v17
    v_rcp_f32 v18, v18
    v_rcp_f32 v19, v19
    v_pk_mul_f32 v[12:13], v[12:13], v[40:41]
    v_pk_mul_f32 v[14:15], v[14:15], v[42:43]
    v_pk_mul_f32 v[16:17], v[16:17], v[44:45]
    v_pk_mul_f32 v[18:19], v[18:19], v[46:47]
    v_cvt_pk_bf16_f32 v20, v12, v13
    v_cvt_pk_bf16_f32 v21, v14, v15
    v_cvt_pk_bf16_f32 v22, v16, v17
    v_cvt_pk_bf16_f32 v23, v18, v19
    buffer_store_dwordx4 v[20:23], v6, s[40:43], 0 offen offset:0 sc1
    v_pk_mul_f32 v[12:13], v[48:49], v[48:49]
    v_pk_mul_f32 v[14:15], v[50:51], v[50:51]
    v_pk_mul_f32 v[16:17], v[52:53], v[52:53]
    v_pk_mul_f32 v[18:19], v[54:55], v[54:55]
    v_pk_fma_f32 v[12:13], v[12:13], v[8:9], v[10:11]
    v_pk_fma_f32 v[14:15], v[14:15], v[8:9], v[10:11]
    v_pk_fma_f32 v[16:17], v[16:17], v[8:9], v[10:11]
    v_pk_fma_f32 v[18:19], v[18:19], v[8:9], v[10:11]
    v_pk_mul_f32 v[12:13], v[12:13], v[48:49]
    v_pk_mul_f32 v[14:15], v[14:15], v[50:51]
    v_pk_mul_f32 v[16:17], v[16:17], v[52:53]
    v_pk_mul_f32 v[18:19], v[18:19], v[54:55]
    v_exp_f32 v12, v12
    v_exp_f32 v13, v13
    v_exp_f32 v14, v14
    v_exp_f32 v15, v15
    v_exp_f32 v16, v16
    v_exp_f32 v17, v17
    v_exp_f32 v18, v18
    v_exp_f32 v19, v19
    v_pk_add_f32 v[12:13], v[12:13], 1.0 op_sel_hi:[1,0]
    v_pk_add_f32 v[14:15], v[14:15], 1.0 op_sel_hi:[1,0]
    v_pk_add_f32 v[16:17], v[16:17], 1.0 op_sel_hi:[1,0]
    v_pk_add_f32 v[18:19], v[18:19], 1.0 op_sel_hi:[1,0]
    v_rcp_f32 v12, v12
    v_rcp_f32 v13, v13
    v_rcp_f32 v14, v14
    v_rcp_f32 v15, v15
    v_rcp_f32 v16, v16
    v_rcp_f32 v17, v17
    v_rcp_f32 v18, v18
    v_rcp_f32 v19, v19
    v_pk_mul_f32 v[12:13], v[12:13], v[48:49]
    v_pk_mul_f32 v[14:15], v[14:15], v[50:51]
    v_pk_mul_f32 v[16:17], v[16:17], v[52:53]
    v_pk_mul_f32 v[18:19], v[18:19], v[54:55]
    v_cvt_pk_bf16_f32 v24, v12, v13
    v_cvt_pk_bf16_f32 v25, v14, v15
    v_cvt_pk_bf16_f32 v26, v16, v17
    v_cvt_pk_bf16_f32 v27, v18, v19
    buffer_store_dwordx4 v[24:27], v6, s[40:43], 0 offen offset:1024 sc1
    v_pk_mul_f32 v[12:13], v[72:73], v[72:73]
    v_pk_mul_f32 v[14:15], v[74:75], v[74:75]
    v_pk_mul_f32 v[16:17], v[76:77], v[76:77]
    v_pk_mul_f32 v[18:19], v[78:79], v[78:79]
    v_pk_fma_f32 v[12:13], v[12:13], v[8:9], v[10:11]
    v_pk_fma_f32 v[14:15], v[14:15], v[8:9], v[10:11]
    v_pk_fma_f32 v[16:17], v[16:17], v[8:9], v[10:11]
    v_pk_fma_f32 v[18:19], v[18:19], v[8:9], v[10:11]
    v_pk_mul_f32 v[12:13], v[12:13], v[72:73]
    v_pk_mul_f32 v[14:15], v[14:15], v[74:75]
    v_pk_mul_f32 v[16:17], v[16:17], v[76:77]
    v_pk_mul_f32 v[18:19], v[18:19], v[78:79]
    v_exp_f32 v12, v12
    v_exp_f32 v13, v13
    v_exp_f32 v14, v14
    v_exp_f32 v15, v15
    v_exp_f32 v16, v16
    v_exp_f32 v17, v17
    v_exp_f32 v18, v18
    v_exp_f32 v19, v19
    v_pk_add_f32 v[12:13], v[12:13], 1.0 op_sel_hi:[1,0]
    v_pk_add_f32 v[14:15], v[14:15], 1.0 op_sel_hi:[1,0]
    v_pk_add_f32 v[16:17], v[16:17], 1.0 op_sel_hi:[1,0]
    v_pk_add_f32 v[18:19], v[18:19], 1.0 op_sel_hi:[1,0]
    v_rcp_f32 v12, v12
    v_rcp_f32 v13, v13
    v_rcp_f32 v14, v14
    v_rcp_f32 v15, v15
    v_rcp_f32 v16, v16
    v_rcp_f32 v17, v17
    v_rcp_f32 v18, v18
    v_rcp_f32 v19, v19
    v_pk_mul_f32 v[12:13], v[12:13], v[72:73]
    v_pk_mul_f32 v[14:15], v[14:15], v[74:75]
    v_pk_mul_f32 v[16:17], v[16:17], v[76:77]
    v_pk_mul_f32 v[18:19], v[18:19], v[78:79]
    v_cvt_pk_bf16_f32 v28, v12, v13
    v_cvt_pk_bf16_f32 v29, v14, v15
    v_cvt_pk_bf16_f32 v30, v16, v17
    v_cvt_pk_bf16_f32 v31, v18, v19
    buffer_store_dwordx4 v[28:31], v6, s[40:43], 0 offen offset:2048 sc1
    v_pk_mul_f32 v[12:13], v[80:81], v[80:81]
    v_pk_mul_f32 v[14:15], v[82:83], v[82:83]
    v_pk_mul_f32 v[16:17], v[84:85], v[84:85]
    v_pk_mul_f32 v[18:19], v[86:87], v[86:87]
    v_pk_fma_f32 v[12:13], v[12:13], v[8:9], v[10:11]
    v_pk_fma_f32 v[14:15], v[14:15], v[8:9], v[10:11]
    v_pk_fma_f32 v[16:17], v[16:17], v[8:9], v[10:11]
    v_pk_fma_f32 v[18:19], v[18:19], v[8:9], v[10:11]
    v_pk_mul_f32 v[12:13], v[12:13], v[80:81]
    v_pk_mul_f32 v[14:15], v[14:15], v[82:83]
    v_pk_mul_f32 v[16:17], v[16:17], v[84:85]
    v_pk_mul_f32 v[18:19], v[18:19], v[86:87]
    v_exp_f32 v12, v12
    v_exp_f32 v13, v13
    v_exp_f32 v14, v14
    v_exp_f32 v15, v15
    v_exp_f32 v16, v16
    v_exp_f32 v17, v17
    v_exp_f32 v18, v18
    v_exp_f32 v19, v19
    v_pk_add_f32 v[12:13], v[12:13], 1.0 op_sel_hi:[1,0]
    v_pk_add_f32 v[14:15], v[14:15], 1.0 op_sel_hi:[1,0]
    v_pk_add_f32 v[16:17], v[16:17], 1.0 op_sel_hi:[1,0]
    v_pk_add_f32 v[18:19], v[18:19], 1.0 op_sel_hi:[1,0]
    v_rcp_f32 v12, v12
    v_rcp_f32 v13, v13
    v_rcp_f32 v14, v14
    v_rcp_f32 v15, v15
    v_rcp_f32 v16, v16
    v_rcp_f32 v17, v17
    v_rcp_f32 v18, v18
    v_rcp_f32 v19, v19
    v_pk_mul_f32 v[12:13], v[12:13], v[80:81]
    v_pk_mul_f32 v[14:15], v[14:15], v[82:83]
    v_pk_mul_f32 v[16:17], v[16:17], v[84:85]
    v_pk_mul_f32 v[18:19], v[18:19], v[86:87]
    v_cvt_pk_bf16_f32 v32, v12, v13
    v_cvt_pk_bf16_f32 v33, v14, v15
    v_cvt_pk_bf16_f32 v34, v16, v17
    v_cvt_pk_bf16_f32 v35, v18, v19
    buffer_store_dwordx4 v[32:35], v6, s[40:43], 0 offen offset:3072 sc1
    v_pk_mul_f32 v[12:13], v[56:57], v[56:57]
    v_pk_mul_f32 v[14:15], v[58:59], v[58:59]
    v_pk_mul_f32 v[16:17], v[60:61], v[60:61]
    v_pk_mul_f32 v[18:19], v[62:63], v[62:63]
    v_pk_fma_f32 v[12:13], v[12:13], v[8:9], v[10:11]
    v_pk_fma_f32 v[14:15], v[14:15], v[8:9], v[10:11]
    v_pk_fma_f32 v[16:17], v[16:17], v[8:9], v[10:11]
    v_pk_fma_f32 v[18:19], v[18:19], v[8:9], v[10:11]
    v_pk_mul_f32 v[12:13], v[12:13], v[56:57]
    v_pk_mul_f32 v[14:15], v[14:15], v[58:59]
    v_pk_mul_f32 v[16:17], v[16:17], v[60:61]
    v_pk_mul_f32 v[18:19], v[18:19], v[62:63]
    v_exp_f32 v12, v12
    v_exp_f32 v13, v13
    v_exp_f32 v14, v14
    v_exp_f32 v15, v15
    v_exp_f32 v16, v16
    v_exp_f32 v17, v17
    v_exp_f32 v18, v18
    v_exp_f32 v19, v19
    v_pk_add_f32 v[12:13], v[12:13], 1.0 op_sel_hi:[1,0]
    v_pk_add_f32 v[14:15], v[14:15], 1.0 op_sel_hi:[1,0]
    v_pk_add_f32 v[16:17], v[16:17], 1.0 op_sel_hi:[1,0]
    v_pk_add_f32 v[18:19], v[18:19], 1.0 op_sel_hi:[1,0]
    v_rcp_f32 v12, v12
    v_rcp_f32 v13, v13
    v_rcp_f32 v14, v14
    v_rcp_f32 v15, v15
    v_rcp_f32 v16, v16
    v_rcp_f32 v17, v17
    v_rcp_f32 v18, v18
    v_rcp_f32 v19, v19
    v_pk_mul_f32 v[12:13], v[12:13], v[56:57]
    v_pk_mul_f32 v[14:15], v[14:15], v[58:59]
    v_pk_mul_f32 v[16:17], v[16:17], v[60:61]
    v_pk_mul_f32 v[18:19], v[18:19], v[62:63]
    v_cvt_pk_bf16_f32 v20, v12, v13
    v_cvt_pk_bf16_f32 v21, v14, v15
    v_cvt_pk_bf16_f32 v22, v16, v17
    v_cvt_pk_bf16_f32 v23, v18, v19
    buffer_store_dwordx4 v[20:23], v6, s[40:43], s73 offen offset:0 sc1
    v_pk_mul_f32 v[12:13], v[64:65], v[64:65]
    v_pk_mul_f32 v[14:15], v[66:67], v[66:67]
    v_pk_mul_f32 v[16:17], v[68:69], v[68:69]
    v_pk_mul_f32 v[18:19], v[70:71], v[70:71]
    v_pk_fma_f32 v[12:13], v[12:13], v[8:9], v[10:11]
    v_pk_fma_f32 v[14:15], v[14:15], v[8:9], v[10:11]
    v_pk_fma_f32 v[16:17], v[16:17], v[8:9], v[10:11]
    v_pk_fma_f32 v[18:19], v[18:19], v[8:9], v[10:11]
    v_pk_mul_f32 v[12:13], v[12:13], v[64:65]
    v_pk_mul_f32 v[14:15], v[14:15], v[66:67]
    v_pk_mul_f32 v[16:17], v[16:17], v[68:69]
    v_pk_mul_f32 v[18:19], v[18:19], v[70:71]
    v_exp_f32 v12, v12
    v_exp_f32 v13, v13
    v_exp_f32 v14, v14
    v_exp_f32 v15, v15
    v_exp_f32 v16, v16
    v_exp_f32 v17, v17
    v_exp_f32 v18, v18
    v_exp_f32 v19, v19
    v_pk_add_f32 v[12:13], v[12:13], 1.0 op_sel_hi:[1,0]
    v_pk_add_f32 v[14:15], v[14:15], 1.0 op_sel_hi:[1,0]
    v_pk_add_f32 v[16:17], v[16:17], 1.0 op_sel_hi:[1,0]
    v_pk_add_f32 v[18:19], v[18:19], 1.0 op_sel_hi:[1,0]
    v_rcp_f32 v12, v12
    v_rcp_f32 v13, v13
    v_rcp_f32 v14, v14
    v_rcp_f32 v15, v15
    v_rcp_f32 v16, v16
    v_rcp_f32 v17, v17
    v_rcp_f32 v18, v18
    v_rcp_f32 v19, v19
    v_pk_mul_f32 v[12:13], v[12:13], v[64:65]
    v_pk_mul_f32 v[14:15], v[14:15], v[66:67]
    v_pk_mul_f32 v[16:17], v[16:17], v[68:69]
    v_pk_mul_f32 v[18:19], v[18:19], v[70:71]
    v_cvt_pk_bf16_f32 v24, v12, v13
    v_cvt_pk_bf16_f32 v25, v14, v15
    v_cvt_pk_bf16_f32 v26, v16, v17
    v_cvt_pk_bf16_f32 v27, v18, v19
    buffer_store_dwordx4 v[24:27], v6, s[40:43], s73 offen offset:1024 sc1
    v_pk_mul_f32 v[12:13], v[88:89], v[88:89]
    v_pk_mul_f32 v[14:15], v[90:91], v[90:91]
    v_pk_mul_f32 v[16:17], v[92:93], v[92:93]
    v_pk_mul_f32 v[18:19], v[94:95], v[94:95]
    v_pk_fma_f32 v[12:13], v[12:13], v[8:9], v[10:11]
    v_pk_fma_f32 v[14:15], v[14:15], v[8:9], v[10:11]
    v_pk_fma_f32 v[16:17], v[16:17], v[8:9], v[10:11]
    v_pk_fma_f32 v[18:19], v[18:19], v[8:9], v[10:11]
    v_pk_mul_f32 v[12:13], v[12:13], v[88:89]
    v_pk_mul_f32 v[14:15], v[14:15], v[90:91]
    v_pk_mul_f32 v[16:17], v[16:17], v[92:93]
    v_pk_mul_f32 v[18:19], v[18:19], v[94:95]
    v_exp_f32 v12, v12
    v_exp_f32 v13, v13
    v_exp_f32 v14, v14
    v_exp_f32 v15, v15
    v_exp_f32 v16, v16
    v_exp_f32 v17, v17
    v_exp_f32 v18, v18
    v_exp_f32 v19, v19
    v_pk_add_f32 v[12:13], v[12:13], 1.0 op_sel_hi:[1,0]
    v_pk_add_f32 v[14:15], v[14:15], 1.0 op_sel_hi:[1,0]
    v_pk_add_f32 v[16:17], v[16:17], 1.0 op_sel_hi:[1,0]
    v_pk_add_f32 v[18:19], v[18:19], 1.0 op_sel_hi:[1,0]
    v_rcp_f32 v12, v12
    v_rcp_f32 v13, v13
    v_rcp_f32 v14, v14
    v_rcp_f32 v15, v15
    v_rcp_f32 v16, v16
    v_rcp_f32 v17, v17
    v_rcp_f32 v18, v18
    v_rcp_f32 v19, v19
    v_pk_mul_f32 v[12:13], v[12:13], v[88:89]
    v_pk_mul_f32 v[14:15], v[14:15], v[90:91]
    v_pk_mul_f32 v[16:17], v[16:17], v[92:93]
    v_pk_mul_f32 v[18:19], v[18:19], v[94:95]
    v_cvt_pk_bf16_f32 v28, v12, v13
    v_cvt_pk_bf16_f32 v29, v14, v15
    v_cvt_pk_bf16_f32 v30, v16, v17
    v_cvt_pk_bf16_f32 v31, v18, v19
    buffer_store_dwordx4 v[28:31], v6, s[40:43], s73 offen offset:2048 sc1
    v_pk_mul_f32 v[12:13], v[96:97], v[96:97]
    v_pk_mul_f32 v[14:15], v[98:99], v[98:99]
    v_pk_mul_f32 v[16:17], v[100:101], v[100:101]
    v_pk_mul_f32 v[18:19], v[102:103], v[102:103]
    v_pk_fma_f32 v[12:13], v[12:13], v[8:9], v[10:11]
    v_pk_fma_f32 v[14:15], v[14:15], v[8:9], v[10:11]
    v_pk_fma_f32 v[16:17], v[16:17], v[8:9], v[10:11]
    v_pk_fma_f32 v[18:19], v[18:19], v[8:9], v[10:11]
    v_pk_mul_f32 v[12:13], v[12:13], v[96:97]
    v_pk_mul_f32 v[14:15], v[14:15], v[98:99]
    v_pk_mul_f32 v[16:17], v[16:17], v[100:101]
    v_pk_mul_f32 v[18:19], v[18:19], v[102:103]
    v_exp_f32 v12, v12
    v_exp_f32 v13, v13
    v_exp_f32 v14, v14
    v_exp_f32 v15, v15
    v_exp_f32 v16, v16
    v_exp_f32 v17, v17
    v_exp_f32 v18, v18
    v_exp_f32 v19, v19
    v_pk_add_f32 v[12:13], v[12:13], 1.0 op_sel_hi:[1,0]
    v_pk_add_f32 v[14:15], v[14:15], 1.0 op_sel_hi:[1,0]
    v_pk_add_f32 v[16:17], v[16:17], 1.0 op_sel_hi:[1,0]
    v_pk_add_f32 v[18:19], v[18:19], 1.0 op_sel_hi:[1,0]
    v_rcp_f32 v12, v12
    v_rcp_f32 v13, v13
    v_rcp_f32 v14, v14
    v_rcp_f32 v15, v15
    v_rcp_f32 v16, v16
    v_rcp_f32 v17, v17
    v_rcp_f32 v18, v18
    v_rcp_f32 v19, v19
    v_pk_mul_f32 v[12:13], v[12:13], v[96:97]
    v_pk_mul_f32 v[14:15], v[14:15], v[98:99]
    v_pk_mul_f32 v[16:17], v[16:17], v[100:101]
    v_pk_mul_f32 v[18:19], v[18:19], v[102:103]
    v_cvt_pk_bf16_f32 v32, v12, v13
    v_cvt_pk_bf16_f32 v33, v14, v15
    v_cvt_pk_bf16_f32 v34, v16, v17
    v_cvt_pk_bf16_f32 v35, v18, v19
    buffer_store_dwordx4 v[32:35], v6, s[40:43], s73 offen offset:3072 sc1
    v_mov_b32 v7, 1
    s_waitcnt vmcnt(0)
    s_mov_b64 exec, 1
    buffer_store_dword v7, off, s[40:43], s71 sc1
    s_mov_b64 exec, -1
    s_branch L_p2_g1
L_attn:
    s_sub_u32 s60, s58, 14
    s_lshl_b32 s59, s57, 1
    s_sub_u32 s77, s60, 9
    s_cmp_ge_u32 s60, 9
    s_cselect_b32 s60, s77, s60
    s_addc_u32 s59, s59, 0
    s_mul_i32 s61, s60, 112
    s_lshl_b32 s77, s76, 1
    v_or_b32 v14, s77, v13
    v_lshlrev_b32 v14, 1, v14
    v_xor_b32 v14, v14, v9
    v_lshlrev_b32 v14, 4, v14
    s_movk_i32 s77, 3072
    v_mad_u32_u24 v35, v12, s77, v14
    s_lshl_b32 s77, s59, 7
    v_add_u32 v35, s77, v35
    v_lshlrev_b32 v21, 4, v0
    s_lshl_b32 s77, s61, 1
    s_add_u32 s77, s77, s56
    s_lshl_b32 s77, s77, 10
    v_add_u32 v33, s77, v33
    v_add_u32 v34, 0x20000, v33
    s_add_u32 s69, s60, s59
    s_and_b32 s69, s69, 7
    s_mul_i32 s69, s69, 1
    s_lshl_b32 s62, s69, 7
    s_mul_i32 s63, s62, 1536
    s_waitcnt lgkmcnt(0)
    s_mov_b32 s28, s4
    s_mov_b32 s29, s5
    s_mov_b32 s30, 2097152
    s_mov_b32 s31, 0x00020000
    s_mov_b32 s32, s6
    s_mov_b32 s33, s7
    s_mov_b32 s34, 1572864
    s_mov_b32 s35, 0x00020000
    s_mov_b32 s48, s20
    s_mov_b32 s49, s21
    s_mov_b32 s50, 1024
    s_mov_b32 s51, 0x00020000
    s_cmp_ge_u32 s3, 2
    s_cbranch_scc1 L_ngw
    s_add_u32 m0, s64, 147456
    s_nop 0
    buffer_load_dwordx4 v21, s[48:51], 0 offen lds
L_ngw:
    s_add_u32 m0, s64, 0
    s_nop 0
    buffer_load_dwordx4 v33, s[28:31], s62 offen lds
    s_add_u32 m0, s64, 8192
    s_nop 0
    buffer_load_dwordx4 v34, s[28:31], s62 offen lds
    s_add_u32 m0, s64, 16384
    s_add_u32 s62, s62, 128
    buffer_load_dwordx4 v35, s[32:35], s63 offen offset:0 lds
    s_add_u32 m0, s64, 23552
    s_and_b32 s62, s62, 1023
    buffer_load_dwordx4 v35, s[32:35], s63 offen offset:1024 lds
    s_add_u32 m0, s64, 30720
    s_nop 0
    buffer_load_dwordx4 v35, s[32:35], s63 offen offset:2048 lds
    s_mul_i32 s63, s62, 1536
    s_mov_b32 s40, s26
    s_mov_b32 s41, s27
    s_mov_b32 s42, 16777216
    s_mov_b32 s43, 0x00020000
    s_sub_u32 s77, s2, 222
    s_cselect_b32 s78, 2147483648, 0
    s_cselect_b32 s77, 0, s77
    s_lshl_b32 s77, s77, 13
    s_add_u32 s77, s77, s64
    s_add_u32 s77, s77, 9502720
    v_add_u32 v20, s78, v21
    v_mov_b32 v16, 0
    v_mov_b32 v17, 0
    v_mov_b32 v18, 0
    v_mov_b32 v19, 0
    buffer_store_dwordx4 v[16:19], v20, s[40:43], s77 offen sc1
    s_barrier
    s_add_u32 m0, s64, 49152
    s_nop 0
    buffer_load_dwordx4 v33, s[28:31], s62 offen lds
    s_add_u32 m0, s64, 57344
    s_nop 0
    buffer_load_dwordx4 v34, s[28:31], s62 offen lds
    s_add_u32 m0, s64, 65536
    s_add_u32 s62, s62, 128
    buffer_load_dwordx4 v35, s[32:35], s63 offen offset:0 lds
    s_sub_u32 s76, s58, 18
    s_cmp_ge_u32 s76, 7
    s_cselect_b32 s67, 1, 0
    s_cselect_b32 s79, 7, 0
    s_sub_u32 s68, s76, s79
    s_cmp_ge_u32 s68, 3
    s_addc_u32 s68, s68, 0
    s_add_u32 s67, s67, 2
    s_sub_u32 s76, s58, 14
    s_cmp_lt_u32 s58, 18
    s_cselect_b32 s68, 3, s68
    s_cselect_b32 s67, s76, s67
    s_lshl_b32 s76, s67, 3
    s_lshr_b32 s70, 150994944, s76
    s_and_b32 s70, s70, 0xff
    s_mov_b32 s40, s26
    s_mov_b32 s41, s27
    s_mov_b32 s42, 16777216
    s_mov_b32 s43, 0x00020000
    s_mov_b32 s44, s22
    s_mov_b32 s45, s23
    s_mov_b32 s46, 2097152
    s_mov_b32 s47, 0x00020000
    s_mov_b32 s52, s24
    s_mov_b32 s53, s25
    s_mov_b32 s54, 256
    s_mov_b32 s55, 0x00020000
    s_mov_b32 s36, s16
    s_mov_b32 s37, s17
    s_mov_b32 s38, 1835008
    s_mov_b32 s39, 0x00020000
    s_lshl_b32 s77, s57, 2
    s_add_u32 s67, s67, s77
    s_lshl_b32 s67, s67, 6
    s_and_b32 s72, s3, 3
    s_mov_b32 s73, 147456
    s_lshl_b32 s78, s68, 7
    v_lshlrev_b32 v14, 2, v13
    v_xor_b32 v14, v14, v9
    v_lshlrev_b32 v14, 4, v14
    v_lshl_add_u32 v14, v8, 10, v14
    v_add_u32 v1, s78, v14
    v_lshl_add_u32 v254, v9, 4, s78
    v_lshrrev_b32 v14, 5, v0
    v_bfe_u32 v15, v0, 2, 2
    v_lshl_add_u32 v14, v14, 3, v15
    v_lshlrev_b32 v14, 7, v14
    v_lshrrev_b32 v15, 1, v15
    v_lshl_add_u32 v14, v15, 6, v14
    v_lshl_add_u32 v14, v13, 5, v14
    v_and_b32 v15, 3, v0
    v_lshl_add_u32 v16, v15, 3, v14
    v_add_u32 v2, s65, v16
    v_xor_b32 v3, 64, v2
    v_add_u32 v4, 0x10000, v2
    v_add_u32 v5, 0x10000, v3
    s_lshl_b32 s77, s56, 5
    s_lshr_b32 s78, s67, 5
    s_add_u32 s77, s77, s78
    s_mul_i32 s77, s77, s73
    v_lshl_add_u32 v252, v0, 4, s77
    v_add_u32 v253, s73, v252
    s_cmp_lt_u32 s3, 4
    s_cselect_b32 s76, 8, 4
    s_cselect_b32 s77, 10, 14
    s_cselect_b32 s80, 0, 72
    s_cselect_b32 s81, 32, 88
    s_mul_i32 s78, s72, s76
    s_add_u32 s78, s78, s80
    s_mul_i32 s79, s72, s77
    s_add_u32 s79, s79, s81
    s_mul_i32 s80, s68, s76
    s_lshr_b32 s80, s80, 3
    s_mul_i32 s81, s68, s77
    s_lshr_b32 s81, s81, 3
    s_sub_u32 s81, s81, s76
    v_min_u32 v16, 17, v0
    v_add_u32 v17, s80, v16
    v_subrev_u32 v18, s76, v17
    v_min_u32 v17, v17, v18
    v_add_u32 v17, s78, v17
    v_add_u32 v18, s81, v16
    v_subrev_u32 v19, s77, v18
    v_min_u32 v18, v18, v19
    v_cmp_gt_u32 vcc, s76, v16
    v_add_u32 v18, s79, v18
    s_nop 0
    v_cndmask_b32 v248, v18, v17, vcc
    v_add_u32 v16, s70, v16
    v_subrev_u32 v17, 18, v16
    v_min_u32 v16, v16, v17
    v_add_u32 v17, s80, v16
    v_subrev_u32 v18, s76, v17
    v_min_u32 v17, v17, v18
    v_add_u32 v17, s78, v17
    v_add_u32 v18, s81, v16
    v_subrev_u32 v19, s77, v18
    v_min_u32 v18, v18, v19
    v_cmp_gt_u32 vcc, s76, v16
    v_add_u32 v18, s79, v18
    s_nop 0
    v_cndmask_b32 v20, v18, v17, vcc
    v_lshlrev_b32 v248, 10, v248
    v_subrev_u32 v17, 32, v20
    v_subrev_u32 v18, 56, v17
    v_cmp_le_u32 vcc, 56, v17
    v_min_u32 v17, v17, v18
    v_and_b32 v18, -8, v17
    v_cndmask_b32 v19, 0, 8, vcc
    v_add3_u32 v17, v17, v18, v19
    v_cmp_gt_u32 vcc, 32, v20
    v_lshlrev_b32 v17, 14, v17
    v_lshl_or_b32 v18, v20, 14, 1
    v_cndmask_b32 v249, v17, v18, vcc
    s_lshl_b32 s80, s56, 4
    s_lshr_b32 s81, s67, 6
    s_add_u32 s80, s80, s81
    s_lshl_b32 s80, s80, 5
    s_mul_i32 s78, s72, s77
    s_add_u32 s79, s78, s77
    s_sub_u32 s79, s79, 1
    s_lshr_b32 s78, s78, 2
    s_lshr_b32 s79, s79, 2
    v_add_u32 v17, s78, v15
    v_min_u32 v17, s79, v17
    s_and_b32 s81, s3, 4
    s_lshl_b32 s81, s81, 2
    s_add_u32 s81, s81, s80
    v_add_u32 v17, s81, v17
    v_lshlrev_b32 v17, 7, v17
    v_add_u32 v251, 9502720, v17
    s_add_u32 s80, s80, s72
    s_add_u32 s80, s80, 10
    s_lshl_b32 s80, s80, 7
    s_add_u32 s80, s80, 9502720
    v_bfe_u32 v17, v0, 3, 1
    v_mul_u32_u24 v17, 48, v17
    v_add_u32 v17, s67, v17
    v_subrev_u32 v18, 16, v17
    v_max_i32 v18, 0, v18
    v_mul_u32_u24 v18, 586, v18
    v_lshrrev_b32 v18, 16, v18
    v_mul_u32_u24 v19, 112, v18
    v_sub_u32 v17, v17, v19
    v_lshrrev_b32 v17, 6, v17
    v_lshl_add_u32 v17, v18, 1, v17
    s_mul_i32 s78, s56, 18
    v_add_u32 v17, s78, v17
    s_lshl_b32 s78, s72, 3
    v_add_u32 v18, s78, v9
    v_cmp_eq_u32 vcc, 0, v13
    v_lshlrev_b32 v17, 5, v17
    s_nop 0
    v_cndmask_b32 v18, v15, v18, vcc
    v_add_u32 v17, v17, v18
    v_lshlrev_b32 v17, 7, v17
    v_add_u32 v17, 9633792, v17
    s_cmp_lt_u32 s3, 4
    s_cselect_b64 vcc, -1, 0
    v_mov_b32 v18, s80
    v_cndmask_b32 v250, v18, v17, vcc
    s_cmp_lg_u32 s3, 0
    s_cselect_b32 s77, 2147483648, 0
    v_min_u32 v7, 33, v0
    v_lshl_add_u32 v7, v7, 2, s77
    s_lshr_b32 s79, s3, 2
    v_and_b32 v17, 15, v0
    v_lshrrev_b32 v18, 1, v17
    v_xor_b32 v18, v18, v10
    v_lshlrev_b32 v18, 4, v18
    v_lshl_add_u32 v18, v17, 7, v18
    s_lshl_b32 s77, s79, 13
    v_add_u32 v21, s77, v18
    v_xor_b32 v22, 64, v21
    s_lshl_b32 s77, s3, 11
    v_add_u32 v23, s77, v18
    v_xor_b32 v24, 64, v23
    v_bfe_u32 v18, v0, 2, 2
    v_lshl_add_u32 v19, v10, 3, v18
    v_lshlrev_b32 v19, 7, v19
    v_lshrrev_b32 v18, 1, v18
    v_lshl_add_u32 v18, v13, 1, v18
    v_xor_b32 v18, s72, v18
    v_lshl_add_u32 v19, v18, 5, v19
    v_lshl_add_u32 v19, v15, 3, v19
    v_add_u32 v29, 16384, v19
    v_add_u32 v30, 49152, v29
    v_add_u32 v31, 98304, v29
    s_lshl_b32 s77, s69, 7
    s_add_u32 s77, s77, 147456
    v_lshl_add_u32 v32, v10, 4, s77
    s_mul_i32 s77, s56, 9
    s_add_u32 s77, s77, s60
    s_lshl_b32 s77, s77, 1
    s_add_u32 s77, s77, s79
    s_lshl_b32 s77, s77, 3
    s_add_u32 s77, s77, s59
    s_lshl_b32 s77, s77, 2
    s_add_u32 s77, s77, s72
    s_lshl_b32 s77, s77, 7
    s_add_u32 s71, s77, 9633792
    v_lshlrev_b32 v18, 2, v10
    v_sub_u32 v17, v17, v18
    v_mov_b32 v38, 0xf149f2ca
    s_cmp_lt_u32 s3, 4
    s_cselect_b32 s79, 64, -8
    v_add_u32 v25, 98304, v21
    v_add_u32 v26, 98304, v22
    v_add_u32 v27, 98304, v23
    v_add_u32 v28, 98304, v24
    v_subrev_u32 v18, 0, v17
    v_cmp_gt_u32 vcc, 8, v18
    v_sub_u32 v19, 0, v18
    s_nop 0
    v_cndmask_b32 v92, v38, 0, vcc
    v_cndmask_b32 v8, 0, -1, vcc
    v_cmp_gt_i32 vcc, -8, v18
    s_nop 1
    v_cndmask_b32 v96, v38, 0, vcc
    v_cmp_lt_i32 vcc, s79, v19
    s_nop 1
    v_cndmask_b32 v100, v38, v96, vcc
    v_subrev_u32 v18, 1, v17
    v_cmp_gt_u32 vcc, 8, v18
    v_sub_u32 v19, 0, v18
    s_nop 0
    v_cndmask_b32 v93, v38, 0, vcc
    v_cndmask_b32 v9, 0, -1, vcc
    v_cmp_gt_i32 vcc, -8, v18
    s_nop 1
    v_cndmask_b32 v97, v38, 0, vcc
    v_cmp_lt_i32 vcc, s79, v19
    s_nop 1
    v_cndmask_b32 v101, v38, v97, vcc
    v_subrev_u32 v18, 2, v17
    v_cmp_gt_u32 vcc, 8, v18
    v_sub_u32 v19, 0, v18
    s_nop 0
    v_cndmask_b32 v94, v38, 0, vcc
    v_cndmask_b32 v10, 0, -1, vcc
    v_cmp_gt_i32 vcc, -8, v18
    s_nop 1
    v_cndmask_b32 v98, v38, 0, vcc
    v_cmp_lt_i32 vcc, s79, v19
    s_nop 1
    v_cndmask_b32 v102, v38, v98, vcc
    v_subrev_u32 v18, 3, v17
    v_cmp_gt_u32 vcc, 8, v18
    v_sub_u32 v19, 0, v18
    s_nop 0
    v_cndmask_b32 v95, v38, 0, vcc
    v_cndmask_b32 v11, 0, -1, vcc
    v_cmp_gt_i32 vcc, -8, v18
    s_nop 1
    v_cndmask_b32 v99, v38, 0, vcc
    v_cmp_lt_i32 vcc, s79, v19
    s_nop 1
    v_cndmask_b32 v103, v38, v99, vcc
    v_alignbit_b32 v36, v9, v8, 16
    v_alignbit_b32 v37, v11, v10, 16
    s_lshl_b32 s75, s58, 3
    s_add_u32 s75, s75, s3
    s_sub_u32 s75, s75, 128
    s_cselect_b32 s77, 2147483648, 0
    s_cselect_b32 s75, 0, s75
    v_lshl_add_u32 v39, v0, 7, s77
    v_and_b32 v12, 0, v0
    v_lshlrev_b32 v12, 2, v12
    s_mov_b32 s78, 3
    v_bfe_u32 v12, s78, v12, 3
    v_lshrrev_b32 v38, 0, v0
    v_lshl_add_u32 v12, v38, 3, v12
    v_lshl_add_u32 v12, v12, 7, s77
    s_waitcnt vmcnt(4)
    s_barrier
    ds_read_b64_tr_b16 v[120:121], v29 offset:0
    ds_read_b64_tr_b16 v[122:123], v29 offset:512
    ds_read_b128 v[104:107], v21 offset:0
    ds_read_b128 v[108:111], v21 offset:2048
    ds_read_b64_tr_b16 v[124:125], v29 offset:8192
    ds_read_b64_tr_b16 v[126:127], v29 offset:8704
    ds_read_b128 v[112:115], v21 offset:4096
    ds_read_b128 v[116:119], v21 offset:6144
    ds_read_b64_tr_b16 v[128:129], v29 offset:16384
    ds_read_b64_tr_b16 v[130:131], v29 offset:16896
    ds_read_b128 v[132:135], v23 offset:0
    ds_read_b128 v[136:139], v32 offset:0
    s_waitcnt lgkmcnt(3)
    ds_read_b64_tr_b16 v[156:157], v29 offset:4096
    ds_read_b64_tr_b16 v[158:159], v29 offset:4608
    ds_read_b128 v[140:143], v22 offset:0
    ds_read_b128 v[144:147], v22 offset:2048
    ds_read_b64_tr_b16 v[160:161], v29 offset:12288
    ds_read_b64_tr_b16 v[162:163], v29 offset:12800
    ds_read_b128 v[148:151], v22 offset:4096
    ds_read_b128 v[152:155], v22 offset:6144
    ds_read_b64_tr_b16 v[164:165], v29 offset:20480
    ds_read_b64_tr_b16 v[166:167], v29 offset:20992
    ds_read_b128 v[168:171], v24 offset:0
    ds_read_b128 v[172:175], v32 offset:64
    s_waitcnt lgkmcnt(12)
    v_mfma_f32_16x16x32_bf16 v[40:43], v[120:123], v[104:107], 0
    s_add_u32 m0, s64, 72704
    s_and_b32 s62, s62, 1023
    buffer_load_dwordx4 v35, s[32:35], s63 offen offset:1024 lds
    v_mfma_f32_16x16x32_bf16 v[56:59], v[124:127], v[104:107], 0
    v_mfma_f32_16x16x32_bf16 v[72:75], v[104:107], v[128:131], 0
    v_mfma_f32_16x16x32_bf16 v[44:47], v[120:123], v[108:111], 0
    v_mfma_f32_16x16x32_bf16 v[60:63], v[124:127], v[108:111], 0
    v_mfma_f32_16x16x32_bf16 v[76:79], v[108:111], v[128:131], 0
    v_mfma_f32_16x16x32_bf16 v[48:51], v[120:123], v[112:115], 0
    s_add_u32 m0, s64, 79872
    s_nop 0
    buffer_load_dwordx4 v35, s[32:35], s63 offen offset:2048 lds
    s_mul_i32 s63, s62, 1536
    v_mfma_f32_16x16x32_bf16 v[64:67], v[124:127], v[112:115], 0
    v_mfma_f32_16x16x32_bf16 v[80:83], v[112:115], v[128:131], 0
    v_mfma_f32_16x16x32_bf16 v[52:55], v[120:123], v[116:119], 0
    v_mfma_f32_16x16x32_bf16 v[68:71], v[124:127], v[116:119], 0
    v_mfma_f32_16x16x32_bf16 v[84:87], v[116:119], v[128:131], 0
    v_mfma_f32_16x16x32_bf16 v[88:91], v[136:139], v[132:135], 0
    s_waitcnt vmcnt(0) lgkmcnt(0)
    s_barrier
    s_cmp_lt_u32 s2, 222
    s_cselect_b32 s77, 1, s3
    s_cmp_lg_u32 s77, 0
    s_cbranch_scc1 L_rd
    v_mov_b32 v8, 1
    s_sub_u32 s77, s2, 222
    s_lshl_b32 s77, s77, 2
    s_mov_b64 exec, 1
    buffer_store_dword v8, off, s[52:55], s77 sc1
    s_mov_b64 exec, -1
L_rd:
    v_mfma_f32_16x16x32_bf16 v[40:43], v[156:159], v[140:143], v[40:43]
    ds_read_b64_tr_b16 v[192:193], v30 offset:0
    ds_read_b64_tr_b16 v[194:195], v30 offset:512
    s_add_u32 m0, s64, 98304
    s_nop 0
    buffer_load_dwordx4 v33, s[28:31], s62 offen lds
    v_mfma_f32_16x16x32_bf16 v[56:59], v[160:163], v[140:143], v[56:59]
    ds_read_b128 v[176:179], v21 offset:49152
    s_add_u32 m0, s64, 106496
    s_nop 0
    buffer_load_dwordx4 v34, s[28:31], s62 offen lds
    ds_read_b128 v[180:183], v21 offset:51200
    v_mfma_f32_16x16x32_bf16 v[72:75], v[140:143], v[164:167], v[72:75]
    ds_read_b64_tr_b16 v[196:197], v30 offset:8192
    s_add_u32 m0, s64, 114688
    s_add_u32 s62, s62, 128
    buffer_load_dwordx4 v35, s[32:35], s63 offen offset:0 lds
    ds_read_b64_tr_b16 v[198:199], v30 offset:8704
    v_mfma_f32_16x16x32_bf16 v[44:47], v[156:159], v[144:147], v[44:47]
    s_add_u32 m0, s64, 121856
    s_and_b32 s62, s62, 1023
    buffer_load_dwordx4 v35, s[32:35], s63 offen offset:1024 lds
    ds_read_b128 v[184:187], v21 offset:53248
    ds_read_b128 v[188:191], v21 offset:55296
    v_mfma_f32_16x16x32_bf16 v[60:63], v[160:163], v[144:147], v[60:63]
    s_add_u32 m0, s64, 129024
    s_nop 0
    buffer_load_dwordx4 v35, s[32:35], s63 offen offset:2048 lds
    s_mul_i32 s63, s62, 1536
    ds_read_b64_tr_b16 v[200:201], v30 offset:16384
    s_add_u32 m0, s64, 0
    s_nop 0
    buffer_load_dwordx4 v33, s[28:31], s62 offen lds
    v_mfma_f32_16x16x32_bf16 v[76:79], v[144:147], v[164:167], v[76:79]
    ds_read_b64_tr_b16 v[202:203], v30 offset:16896
    ds_read_b128 v[204:207], v23 offset:49152
    s_add_u32 m0, s64, 8192
    s_nop 0
    buffer_load_dwordx4 v34, s[28:31], s62 offen lds
    v_mfma_f32_16x16x32_bf16 v[48:51], v[156:159], v[148:151], v[48:51]
    ds_read_b128 v[208:211], v32 offset:128
    ds_read_b64_tr_b16 v[228:229], v30 offset:4096
    s_add_u32 m0, s64, 16384
    s_add_u32 s62, s62, 128
    buffer_load_dwordx4 v35, s[32:35], s63 offen offset:0 lds
    v_mfma_f32_16x16x32_bf16 v[64:67], v[160:163], v[148:151], v[64:67]
    ds_read_b64_tr_b16 v[230:231], v30 offset:4608
    s_add_u32 m0, s64, 23552
    s_and_b32 s62, s62, 1023
    buffer_load_dwordx4 v35, s[32:35], s63 offen offset:1024 lds
    ds_read_b128 v[212:215], v22 offset:49152
    v_mfma_f32_16x16x32_bf16 v[80:83], v[148:151], v[164:167], v[80:83]
    s_waitcnt lgkmcnt(6)
    ds_read_b128 v[216:219], v22 offset:51200
    s_add_u32 m0, s64, 30720
    s_nop 0
    buffer_load_dwordx4 v35, s[32:35], s63 offen offset:2048 lds
    s_mul_i32 s63, s62, 1536
    ds_read_b64_tr_b16 v[232:233], v30 offset:12288
    v_mfma_f32_16x16x32_bf16 v[52:55], v[156:159], v[152:155], v[52:55]
    s_mov_b32 s36, s8
    s_mov_b32 s37, s9
    s_and_b32 s81, s2, 7
    s_lshl_b32 s81, s81, 7
    s_add_u32 s81, s81, s75
    s_mul_i32 s81, s81, 512
    s_mov_b64 exec, 15
    buffer_load_dword v38, v39, s[36:39], s81 offen
    s_mov_b64 exec, -1
    ds_read_b64_tr_b16 v[234:235], v30 offset:12800
    ds_read_b128 v[220:223], v22 offset:53248
    v_mfma_f32_16x16x32_bf16 v[68:71], v[160:163], v[152:155], v[68:71]
    s_mov_b32 s36, s16
    s_mov_b32 s37, s17
    s_and_b32 s81, s2, 7
    s_lshl_b32 s81, s81, 7
    s_add_u32 s81, s81, s75
    s_mul_i32 s81, s81, 1792
    s_mov_b64 exec, 16383
    buffer_load_dword v38, v39, s[36:39], s81 offen
    s_mov_b64 exec, -1
    ds_read_b128 v[224:227], v22 offset:55296
    ds_read_b64_tr_b16 v[236:237], v30 offset:20480
    v_mfma_f32_16x16x32_bf16 v[84:87], v[152:155], v[164:167], v[84:87]
    ds_read_b64_tr_b16 v[238:239], v30 offset:20992
    ds_read_b128 v[240:243], v24 offset:49152
    ds_read_b128 v[244:247], v32 offset:192
    v_mfma_f32_16x16x32_bf16 v[88:91], v[172:175], v[168:171], v[88:91]
    s_waitcnt lgkmcnt(12)
    v_mfma_f32_16x16x32_bf16 v[40:43], v[192:195], v[176:179], v[40:43]
    v_mfma_f32_16x16x32_bf16 v[56:59], v[196:199], v[176:179], v[56:59]
    v_mfma_f32_16x16x32_bf16 v[72:75], v[176:179], v[200:203], v[72:75]
    v_mfma_f32_16x16x32_bf16 v[44:47], v[192:195], v[180:183], v[44:47]
    s_waitcnt vmcnt(7) lgkmcnt(0)
    s_barrier
    v_mfma_f32_16x16x32_bf16 v[60:63], v[196:199], v[180:183], v[60:63]
    ds_read_b64_tr_b16 v[120:121], v31 offset:0
    ds_read_b64_tr_b16 v[122:123], v31 offset:512
    v_mfma_f32_16x16x32_bf16 v[76:79], v[180:183], v[200:203], v[76:79]
    s_add_u32 m0, s64, 49152
    s_nop 0
    buffer_load_dwordx4 v33, s[28:31], s62 offen lds
    ds_read_b128 v[104:107], v25 offset:0
    v_mfma_f32_16x16x32_bf16 v[48:51], v[192:195], v[184:187], v[48:51]
    ds_read_b128 v[108:111], v25 offset:2048
    v_mfma_f32_16x16x32_bf16 v[64:67], v[196:199], v[184:187], v[64:67]
    ds_read_b64_tr_b16 v[124:125], v31 offset:8192
    s_add_u32 m0, s64, 57344
    s_nop 0
    buffer_load_dwordx4 v34, s[28:31], s62 offen lds
    v_mfma_f32_16x16x32_bf16 v[80:83], v[184:187], v[200:203], v[80:83]
    ds_read_b64_tr_b16 v[126:127], v31 offset:8704
    v_mfma_f32_16x16x32_bf16 v[52:55], v[192:195], v[188:191], v[52:55]
    ds_read_b128 v[112:115], v25 offset:4096
    ds_read_b128 v[116:119], v25 offset:6144
    v_mfma_f32_16x16x32_bf16 v[68:71], v[196:199], v[188:191], v[68:71]
    ds_read_b64_tr_b16 v[128:129], v31 offset:16384
    v_mfma_f32_16x16x32_bf16 v[84:87], v[188:191], v[200:203], v[84:87]
    s_add_u32 m0, s64, 65536
    s_add_u32 s62, s62, 128
    buffer_load_dwordx4 v35, s[32:35], s63 offen offset:0 lds
    ds_read_b64_tr_b16 v[130:131], v31 offset:16896
    v_mfma_f32_16x16x32_bf16 v[88:91], v[208:211], v[204:207], v[88:91]
    ds_read_b128 v[132:135], v27 offset:0
    v_mfma_f32_16x16x32_bf16 v[40:43], v[228:231], v[212:215], v[40:43]
    ds_read_b128 v[136:139], v32 offset:256
    ds_read_b64_tr_b16 v[156:157], v31 offset:4096
    v_mfma_f32_16x16x32_bf16 v[56:59], v[232:235], v[212:215], v[56:59]
    s_add_u32 m0, s64, 72704
    s_and_b32 s62, s62, 1023
    buffer_load_dwordx4 v35, s[32:35], s63 offen offset:1024 lds
    v_mfma_f32_16x16x32_bf16 v[72:75], v[212:215], v[236:239], v[72:75]
    ds_read_b64_tr_b16 v[158:159], v31 offset:4608
    ds_read_b128 v[140:143], v26 offset:0
    v_mfma_f32_16x16x32_bf16 v[44:47], v[228:231], v[216:219], v[44:47]
    s_waitcnt lgkmcnt(6)
    ds_read_b128 v[144:147], v26 offset:2048
    v_mfma_f32_16x16x32_bf16 v[60:63], v[232:235], v[216:219], v[60:63]
    ds_read_b64_tr_b16 v[160:161], v31 offset:12288
    s_add_u32 m0, s64, 79872
    s_nop 0
    buffer_load_dwordx4 v35, s[32:35], s63 offen offset:2048 lds
    s_mul_i32 s63, s62, 1536
    v_mfma_f32_16x16x32_bf16 v[76:79], v[216:219], v[236:239], v[76:79]
    ds_read_b64_tr_b16 v[162:163], v31 offset:12800
    v_mfma_f32_16x16x32_bf16 v[48:51], v[228:231], v[220:223], v[48:51]
    ds_read_b128 v[148:151], v26 offset:4096
    ds_read_b128 v[152:155], v26 offset:6144
    v_mfma_f32_16x16x32_bf16 v[64:67], v[232:235], v[220:223], v[64:67]
    ds_read_b64_tr_b16 v[164:165], v31 offset:20480
    v_mfma_f32_16x16x32_bf16 v[80:83], v[220:223], v[236:239], v[80:83]
    ds_read_b64_tr_b16 v[166:167], v31 offset:20992
    ds_read_b128 v[168:171], v28 offset:0
    v_mfma_f32_16x16x32_bf16 v[52:55], v[228:231], v[224:227], v[52:55]
    ds_read_b128 v[172:175], v32 offset:320
    v_mfma_f32_16x16x32_bf16 v[68:71], v[232:235], v[224:227], v[68:71]
    v_mfma_f32_16x16x32_bf16 v[84:87], v[224:227], v[236:239], v[84:87]
    v_mfma_f32_16x16x32_bf16 v[88:91], v[244:247], v[240:243], v[88:91]
    s_waitcnt lgkmcnt(12)
    v_mfma_f32_16x16x32_bf16 v[40:43], v[120:123], v[104:107], v[40:43]
    v_mfma_f32_16x16x32_bf16 v[56:59], v[124:127], v[104:107], v[56:59]
    v_mfma_f32_16x16x32_bf16 v[72:75], v[104:107], v[128:131], v[72:75]
    v_mfma_f32_16x16x32_bf16 v[44:47], v[120:123], v[108:111], v[44:47]
    s_waitcnt vmcnt(7) lgkmcnt(0)
    s_barrier
    v_mfma_f32_16x16x32_bf16 v[60:63], v[124:127], v[108:111], v[60:63]
    ds_read_b64_tr_b16 v[192:193], v29 offset:0
    ds_read_b64_tr_b16 v[194:195], v29 offset:512
    v_mfma_f32_16x16x32_bf16 v[76:79], v[108:111], v[128:131], v[76:79]
    s_add_u32 m0, s64, 98304
    s_nop 0
    buffer_load_dwordx4 v33, s[28:31], s62 offen lds
    ds_read_b128 v[176:179], v21 offset:0
    v_mfma_f32_16x16x32_bf16 v[48:51], v[120:123], v[112:115], v[48:51]
    ds_read_b128 v[180:183], v21 offset:2048
    v_mfma_f32_16x16x32_bf16 v[64:67], v[124:127], v[112:115], v[64:67]
    ds_read_b64_tr_b16 v[196:197], v29 offset:8192
    s_add_u32 m0, s64, 106496
    s_nop 0
    buffer_load_dwordx4 v34, s[28:31], s62 offen lds
    v_mfma_f32_16x16x32_bf16 v[80:83], v[112:115], v[128:131], v[80:83]
    ds_read_b64_tr_b16 v[198:199], v29 offset:8704
    v_mfma_f32_16x16x32_bf16 v[52:55], v[120:123], v[116:119], v[52:55]
    ds_read_b128 v[184:187], v21 offset:4096
    ds_read_b128 v[188:191], v21 offset:6144
    v_mfma_f32_16x16x32_bf16 v[68:71], v[124:127], v[116:119], v[68:71]
    ds_read_b64_tr_b16 v[200:201], v29 offset:16384
    v_mfma_f32_16x16x32_bf16 v[84:87], v[116:119], v[128:131], v[84:87]
    s_add_u32 m0, s64, 114688
    s_add_u32 s62, s62, 128
    buffer_load_dwordx4 v35, s[32:35], s63 offen offset:0 lds
    ds_read_b64_tr_b16 v[202:203], v29 offset:16896
    v_mfma_f32_16x16x32_bf16 v[88:91], v[136:139], v[132:135], v[88:91]
    ds_read_b128 v[204:207], v23 offset:0
    v_mfma_f32_16x16x32_bf16 v[40:43], v[156:159], v[140:143], v[40:43]
    ds_read_b128 v[208:211], v32 offset:384
    ds_read_b64_tr_b16 v[228:229], v29 offset:4096
    v_mfma_f32_16x16x32_bf16 v[56:59], v[160:163], v[140:143], v[56:59]
    s_add_u32 m0, s64, 121856
    s_and_b32 s62, s62, 1023
    buffer_load_dwordx4 v35, s[32:35], s63 offen offset:1024 lds
    v_mfma_f32_16x16x32_bf16 v[72:75], v[140:143], v[164:167], v[72:75]
    ds_read_b64_tr_b16 v[230:231], v29 offset:4608
    ds_read_b128 v[212:215], v22 offset:0
    v_mfma_f32_16x16x32_bf16 v[44:47], v[156:159], v[144:147], v[44:47]
    s_waitcnt lgkmcnt(6)
    ds_read_b128 v[216:219], v22 offset:2048
    v_mfma_f32_16x16x32_bf16 v[60:63], v[160:163], v[144:147], v[60:63]
    ds_read_b64_tr_b16 v[232:233], v29 offset:12288
    s_add_u32 m0, s64, 129024
    s_nop 0
    buffer_load_dwordx4 v35, s[32:35], s63 offen offset:2048 lds
    s_mul_i32 s63, s62, 1536
    v_mfma_f32_16x16x32_bf16 v[76:79], v[144:147], v[164:167], v[76:79]
    ds_read_b64_tr_b16 v[234:235], v29 offset:12800
    v_mfma_f32_16x16x32_bf16 v[48:51], v[156:159], v[148:151], v[48:51]
    ds_read_b128 v[220:223], v22 offset:4096
    ds_read_b128 v[224:227], v22 offset:6144
    v_mfma_f32_16x16x32_bf16 v[64:67], v[160:163], v[148:151], v[64:67]
    ds_read_b64_tr_b16 v[236:237], v29 offset:20480
    v_mfma_f32_16x16x32_bf16 v[80:83], v[148:151], v[164:167], v[80:83]
    ds_read_b64_tr_b16 v[238:239], v29 offset:20992
    ds_read_b128 v[240:243], v24 offset:0
    v_mfma_f32_16x16x32_bf16 v[52:55], v[156:159], v[152:155], v[52:55]
    ds_read_b128 v[244:247], v32 offset:448
    v_mfma_f32_16x16x32_bf16 v[68:71], v[160:163], v[152:155], v[68:71]
    v_mfma_f32_16x16x32_bf16 v[84:87], v[152:155], v[164:167], v[84:87]
    v_mfma_f32_16x16x32_bf16 v[88:91], v[172:175], v[168:171], v[88:91]
    s_waitcnt lgkmcnt(12)
    v_mfma_f32_16x16x32_bf16 v[40:43], v[192:195], v[176:179], v[40:43]
    v_mfma_f32_16x16x32_bf16 v[56:59], v[196:199], v[176:179], v[56:59]
    v_mfma_f32_16x16x32_bf16 v[72:75], v[176:179], v[200:203], v[72:75]
    v_mfma_f32_16x16x32_bf16 v[44:47], v[192:195], v[180:183], v[44:47]
    s_waitcnt vmcnt(5) lgkmcnt(0)
    s_barrier
    v_mfma_f32_16x16x32_bf16 v[60:63], v[196:199], v[180:183], v[60:63]
    ds_read_b64_tr_b16 v[120:121], v30 offset:0
    ds_read_b64_tr_b16 v[122:123], v30 offset:512
    v_mfma_f32_16x16x32_bf16 v[76:79], v[180:183], v[200:203], v[76:79]
    buffer_load_dword v7, v7, s[52:55], 0 offen sc1
    ds_read_b128 v[104:107], v21 offset:49152
    v_mfma_f32_16x16x32_bf16 v[48:51], v[192:195], v[184:187], v[48:51]
    ds_read_b128 v[108:111], v21 offset:51200
    v_mfma_f32_16x16x32_bf16 v[64:67], v[196:199], v[184:187], v[64:67]
    ds_read_b64_tr_b16 v[124:125], v30 offset:8192
    s_add_u32 m0, s64, 0
    s_nop 0
    buffer_load_dwordx4 v33, s[28:31], s62 offen lds
    v_mfma_f32_16x16x32_bf16 v[80:83], v[184:187], v[200:203], v[80:83]
    ds_read_b64_tr_b16 v[126:127], v30 offset:8704
    v_mfma_f32_16x16x32_bf16 v[52:55], v[192:195], v[188:191], v[52:55]
    ds_read_b128 v[112:115], v21 offset:53248
    ds_read_b128 v[116:119], v21 offset:55296
    v_mfma_f32_16x16x32_bf16 v[68:71], v[196:199], v[188:191], v[68:71]
    s_add_u32 m0, s64, 8192
    s_nop 0
    buffer_load_dwordx4 v34, s[28:31], s62 offen lds
    ds_read_b64_tr_b16 v[128:129], v30 offset:16384
    v_mfma_f32_16x16x32_bf16 v[84:87], v[188:191], v[200:203], v[84:87]
    ds_read_b64_tr_b16 v[130:131], v30 offset:16896
    v_mfma_f32_16x16x32_bf16 v[88:91], v[208:211], v[204:207], v[88:91]
    ds_read_b128 v[132:135], v23 offset:49152
    s_add_u32 m0, s64, 16384
    s_add_u32 s62, s62, 128
    buffer_load_dwordx4 v35, s[32:35], s63 offen offset:0 lds
    v_mfma_f32_16x16x32_bf16 v[40:43], v[228:231], v[212:215], v[40:43]
    ds_read_b128 v[136:139], v32 offset:512
    v_mfma_f32_16x16x32_bf16 v[56:59], v[232:235], v[212:215], v[56:59]
    ds_read_b64_tr_b16 v[156:157], v30 offset:4096
    ds_read_b64_tr_b16 v[158:159], v30 offset:4608
    v_mfma_f32_16x16x32_bf16 v[72:75], v[212:215], v[236:239], v[72:75]
    s_add_u32 m0, s64, 23552
    s_and_b32 s62, s62, 1023
    buffer_load_dwordx4 v35, s[32:35], s63 offen offset:1024 lds
    v_mfma_f32_16x16x32_bf16 v[44:47], v[228:231], v[216:219], v[44:47]
    ds_read_b128 v[140:143], v22 offset:49152
    s_waitcnt lgkmcnt(6)
    ds_read_b128 v[144:147], v22 offset:51200
    v_mfma_f32_16x16x32_bf16 v[60:63], v[232:235], v[216:219], v[60:63]
    ds_read_b64_tr_b16 v[160:161], v30 offset:12288
    s_add_u32 m0, s64, 30720
    s_nop 0
    buffer_load_dwordx4 v35, s[32:35], s63 offen offset:2048 lds
    s_mul_i32 s63, s62, 1536
    v_mfma_f32_16x16x32_bf16 v[76:79], v[216:219], v[236:239], v[76:79]
    ds_read_b64_tr_b16 v[162:163], v30 offset:12800
    v_mfma_f32_16x16x32_bf16 v[48:51], v[228:231], v[220:223], v[48:51]
    ds_read_b128 v[148:151], v22 offset:53248
    ds_read_b128 v[152:155], v22 offset:55296
    v_mfma_f32_16x16x32_bf16 v[64:67], v[232:235], v[220:223], v[64:67]
    ds_read_b64_tr_b16 v[164:165], v30 offset:20480
    v_mfma_f32_16x16x32_bf16 v[80:83], v[220:223], v[236:239], v[80:83]
    ds_read_b64_tr_b16 v[166:167], v30 offset:20992
    ds_read_b128 v[168:171], v24 offset:49152
    v_mfma_f32_16x16x32_bf16 v[52:55], v[228:231], v[224:227], v[52:55]
    ds_read_b128 v[172:175], v32 offset:576
    v_mfma_f32_16x16x32_bf16 v[68:71], v[232:235], v[224:227], v[68:71]
    v_mfma_f32_16x16x32_bf16 v[84:87], v[224:227], v[236:239], v[84:87]
    v_mfma_f32_16x16x32_bf16 v[88:91], v[244:247], v[240:243], v[88:91]
    s_waitcnt lgkmcnt(12)
    v_mfma_f32_16x16x32_bf16 v[40:43], v[120:123], v[104:107], v[40:43]
    v_mfma_f32_16x16x32_bf16 v[56:59], v[124:127], v[104:107], v[56:59]
    v_mfma_f32_16x16x32_bf16 v[72:75], v[104:107], v[128:131], v[72:75]
    v_mfma_f32_16x16x32_bf16 v[44:47], v[120:123], v[108:111], v[44:47]
    s_waitcnt vmcnt(6) lgkmcnt(0)
    s_barrier
    v_mfma_f32_16x16x32_bf16 v[60:63], v[124:127], v[108:111], v[60:63]
    ds_read_b64_tr_b16 v[192:193], v31 offset:0
    ds_read_b64_tr_b16 v[194:195], v31 offset:512
    v_mfma_f32_16x16x32_bf16 v[76:79], v[108:111], v[128:131], v[76:79]
    s_add_u32 m0, s64, 49152
    s_nop 0
    buffer_load_dwordx4 v33, s[28:31], s62 offen lds
    ds_read_b128 v[176:179], v25 offset:0
    v_mfma_f32_16x16x32_bf16 v[48:51], v[120:123], v[112:115], v[48:51]
    ds_read_b128 v[180:183], v25 offset:2048
    v_mfma_f32_16x16x32_bf16 v[64:67], v[124:127], v[112:115], v[64:67]
    ds_read_b64_tr_b16 v[196:197], v31 offset:8192
    s_add_u32 m0, s64, 57344
    s_nop 0
    buffer_load_dwordx4 v34, s[28:31], s62 offen lds
    v_mfma_f32_16x16x32_bf16 v[80:83], v[112:115], v[128:131], v[80:83]
    ds_read_b64_tr_b16 v[198:199], v31 offset:8704
    v_mfma_f32_16x16x32_bf16 v[52:55], v[120:123], v[116:119], v[52:55]
    ds_read_b128 v[184:187], v25 offset:4096
    ds_read_b128 v[188:191], v25 offset:6144
    v_mfma_f32_16x16x32_bf16 v[68:71], v[124:127], v[116:119], v[68:71]
    ds_read_b64_tr_b16 v[200:201], v31 offset:16384
    v_mfma_f32_16x16x32_bf16 v[84:87], v[116:119], v[128:131], v[84:87]
    s_add_u32 m0, s64, 65536
    s_add_u32 s62, s62, 128
    buffer_load_dwordx4 v35, s[32:35], s63 offen offset:0 lds
    ds_read_b64_tr_b16 v[202:203], v31 offset:16896
    v_mfma_f32_16x16x32_bf16 v[88:91], v[136:139], v[132:135], v[88:91]
    ds_read_b128 v[204:207], v27 offset:0
    v_mfma_f32_16x16x32_bf16 v[40:43], v[156:159], v[140:143], v[40:43]
    ds_read_b128 v[208:211], v32 offset:640
    ds_read_b64_tr_b16 v[228:229], v31 offset:4096
    v_mfma_f32_16x16x32_bf16 v[56:59], v[160:163], v[140:143], v[56:59]
    s_add_u32 m0, s64, 72704
    s_and_b32 s62, s62, 1023
    buffer_load_dwordx4 v35, s[32:35], s63 offen offset:1024 lds
    v_mfma_f32_16x16x32_bf16 v[72:75], v[140:143], v[164:167], v[72:75]
    ds_read_b64_tr_b16 v[230:231], v31 offset:4608
    ds_read_b128 v[212:215], v26 offset:0
    v_mfma_f32_16x16x32_bf16 v[44:47], v[156:159], v[144:147], v[44:47]
    s_waitcnt lgkmcnt(6)
    ds_read_b128 v[216:219], v26 offset:2048
    v_mfma_f32_16x16x32_bf16 v[60:63], v[160:163], v[144:147], v[60:63]
    ds_read_b64_tr_b16 v[232:233], v31 offset:12288
    s_add_u32 m0, s64, 79872
    s_nop 0
    buffer_load_dwordx4 v35, s[32:35], s63 offen offset:2048 lds
    s_mul_i32 s63, s62, 1536
    v_mfma_f32_16x16x32_bf16 v[76:79], v[144:147], v[164:167], v[76:79]
    ds_read_b64_tr_b16 v[234:235], v31 offset:12800
    v_mfma_f32_16x16x32_bf16 v[48:51], v[156:159], v[148:151], v[48:51]
    ds_read_b128 v[220:223], v26 offset:4096
    ds_read_b128 v[224:227], v26 offset:6144
    v_mfma_f32_16x16x32_bf16 v[64:67], v[160:163], v[148:151], v[64:67]
    ds_read_b64_tr_b16 v[236:237], v31 offset:20480
    v_mfma_f32_16x16x32_bf16 v[80:83], v[148:151], v[164:167], v[80:83]
    ds_read_b64_tr_b16 v[238:239], v31 offset:20992
    ds_read_b128 v[240:243], v28 offset:0
    v_mfma_f32_16x16x32_bf16 v[52:55], v[156:159], v[152:155], v[52:55]
    ds_read_b128 v[244:247], v32 offset:704
    v_mfma_f32_16x16x32_bf16 v[68:71], v[160:163], v[152:155], v[68:71]
    v_mfma_f32_16x16x32_bf16 v[84:87], v[152:155], v[164:167], v[84:87]
    v_mfma_f32_16x16x32_bf16 v[88:91], v[172:175], v[168:171], v[88:91]
    s_waitcnt lgkmcnt(12)
    v_mfma_f32_16x16x32_bf16 v[40:43], v[192:195], v[176:179], v[40:43]
    v_mfma_f32_16x16x32_bf16 v[56:59], v[196:199], v[176:179], v[56:59]
    v_mfma_f32_16x16x32_bf16 v[72:75], v[176:179], v[200:203], v[72:75]
    v_mfma_f32_16x16x32_bf16 v[44:47], v[192:195], v[180:183], v[44:47]
    s_waitcnt vmcnt(5) lgkmcnt(0)
    s_cmp_lg_u32 s3, 0
    s_cbranch_scc1 L_a_e1
L_a_e0:
    v_cmp_ne_u32 vcc, 1, v7
    s_cbranch_vccz L_a_e1
    s_add_u32 s66, s66, 1
    s_cmp_ge_u32 s66, 262144
    s_cbranch_scc1 L_a_e1
    v_min_u32 v7, 33, v0
    v_lshlrev_b32 v7, 2, v7
    buffer_load_dword v7, v7, s[52:55], 0 offen sc1
    s_waitcnt vmcnt(0)
    s_branch L_a_e0
L_a_e1:
    s_barrier
    v_mfma_f32_16x16x32_bf16 v[60:63], v[196:199], v[180:183], v[60:63]
    ds_read_b64_tr_b16 v[120:121], v29 offset:0
    ds_read_b64_tr_b16 v[122:123], v29 offset:512
    v_mfma_f32_16x16x32_bf16 v[76:79], v[180:183], v[200:203], v[76:79]
    v_readlane_b32 s80, v249, 0
    s_add_u32 m0, s65, 98304
    s_bitcmp1_b32 s80, 0
    s_cselect_b32 s36, s8, s16
    s_cselect_b32 s37, s9, s17
    s_and_b32 s81, s80, -2
    buffer_load_dwordx4 v1, s[36:39], s81 offen lds
    ds_read_b128 v[104:107], v21 offset:0
    v_mfma_f32_16x16x32_bf16 v[48:51], v[192:195], v[184:187], v[48:51]
    ds_read_b128 v[108:111], v21 offset:2048
    v_mfma_f32_16x16x32_bf16 v[64:67], v[196:199], v[184:187], v[64:67]
    ds_read_b64_tr_b16 v[124:125], v29 offset:8192
    s_add_u32 m0, s65, 99328
    s_add_u32 s81, s81, 8192
    buffer_load_dwordx4 v1, s[36:39], s81 offen lds
    v_mfma_f32_16x16x32_bf16 v[80:83], v[184:187], v[200:203], v[80:83]
    ds_read_b64_tr_b16 v[126:127], v29 offset:8704
    v_mfma_f32_16x16x32_bf16 v[52:55], v[192:195], v[188:191], v[52:55]
    ds_read_b128 v[112:115], v21 offset:4096
    ds_read_b128 v[116:119], v21 offset:6144
    v_mfma_f32_16x16x32_bf16 v[68:71], v[196:199], v[188:191], v[68:71]
    v_readlane_b32 s80, v249, 1
    s_add_u32 m0, s65, 100352
    s_bitcmp1_b32 s80, 0
    s_cselect_b32 s36, s8, s16
    s_cselect_b32 s37, s9, s17
    s_and_b32 s81, s80, -2
    buffer_load_dwordx4 v1, s[36:39], s81 offen lds
    ds_read_b64_tr_b16 v[128:129], v29 offset:16384
    v_mfma_f32_16x16x32_bf16 v[84:87], v[188:191], v[200:203], v[84:87]
    ds_read_b64_tr_b16 v[130:131], v29 offset:16896
    v_mfma_f32_16x16x32_bf16 v[88:91], v[208:211], v[204:207], v[88:91]
    ds_read_b128 v[132:135], v23 offset:0
    s_add_u32 m0, s65, 101376
    s_add_u32 s81, s81, 8192
    buffer_load_dwordx4 v1, s[36:39], s81 offen lds
    v_mfma_f32_16x16x32_bf16 v[40:43], v[228:231], v[212:215], v[40:43]
    ds_read_b128 v[136:139], v32 offset:768
    v_mfma_f32_16x16x32_bf16 v[56:59], v[232:235], v[212:215], v[56:59]
    ds_read_b64_tr_b16 v[156:157], v29 offset:4096
    ds_read_b64_tr_b16 v[158:159], v29 offset:4608
    v_mfma_f32_16x16x32_bf16 v[72:75], v[212:215], v[236:239], v[72:75]
    v_readlane_b32 s80, v249, 2
    s_add_u32 m0, s65, 102400
    s_bitcmp1_b32 s80, 0
    s_cselect_b32 s36, s8, s16
    s_cselect_b32 s37, s9, s17
    s_and_b32 s81, s80, -2
    buffer_load_dwordx4 v1, s[36:39], s81 offen lds
    v_mfma_f32_16x16x32_bf16 v[44:47], v[228:231], v[216:219], v[44:47]
    ds_read_b128 v[140:143], v22 offset:0
    s_waitcnt lgkmcnt(6)
    ds_read_b128 v[144:147], v22 offset:2048
    v_mfma_f32_16x16x32_bf16 v[60:63], v[232:235], v[216:219], v[60:63]
    ds_read_b64_tr_b16 v[160:161], v29 offset:12288
    s_add_u32 m0, s65, 103424
    s_add_u32 s81, s81, 8192
    buffer_load_dwordx4 v1, s[36:39], s81 offen lds
    v_mfma_f32_16x16x32_bf16 v[76:79], v[216:219], v[236:239], v[76:79]
    ds_read_b64_tr_b16 v[162:163], v29 offset:12800
    v_mfma_f32_16x16x32_bf16 v[48:51], v[228:231], v[220:223], v[48:51]
    ds_read_b128 v[148:151], v22 offset:4096
    ds_read_b128 v[152:155], v22 offset:6144
    v_mfma_f32_16x16x32_bf16 v[64:67], v[232:235], v[220:223], v[64:67]
    ds_read_b64_tr_b16 v[164:165], v29 offset:20480
    v_mfma_f32_16x16x32_bf16 v[80:83], v[220:223], v[236:239], v[80:83]
    ds_read_b64_tr_b16 v[166:167], v29 offset:20992
    ds_read_b128 v[168:171], v24 offset:0
    v_mfma_f32_16x16x32_bf16 v[52:55], v[228:231], v[224:227], v[52:55]
    ds_read_b128 v[172:175], v32 offset:832
    v_mfma_f32_16x16x32_bf16 v[68:71], v[232:235], v[224:227], v[68:71]
    v_mfma_f32_16x16x32_bf16 v[84:87], v[224:227], v[236:239], v[84:87]
    v_mfma_f32_16x16x32_bf16 v[88:91], v[244:247], v[240:243], v[88:91]
    s_waitcnt lgkmcnt(12)
    v_mfma_f32_16x16x32_bf16 v[40:43], v[120:123], v[104:107], v[40:43]
    v_mfma_f32_16x16x32_bf16 v[56:59], v[124:127], v[104:107], v[56:59]
    v_mfma_f32_16x16x32_bf16 v[72:75], v[104:107], v[128:131], v[72:75]
    v_mfma_f32_16x16x32_bf16 v[44:47], v[120:123], v[108:111], v[44:47]
    s_waitcnt vmcnt(6) lgkmcnt(0)
    s_barrier
    v_mfma_f32_16x16x32_bf16 v[60:63], v[124:127], v[108:111], v[60:63]
    ds_read_b64_tr_b16 v[192:193], v30 offset:0
    ds_read_b64_tr_b16 v[194:195], v30 offset:512
    v_mfma_f32_16x16x32_bf16 v[76:79], v[108:111], v[128:131], v[76:79]
    v_readlane_b32 s80, v249, 3
    s_add_u32 m0, s65, 0
    s_bitcmp1_b32 s80, 0
    s_cselect_b32 s36, s8, s16
    s_cselect_b32 s37, s9, s17
    s_and_b32 s81, s80, -2
    buffer_load_dwordx4 v1, s[36:39], s81 offen lds
    ds_read_b128 v[176:179], v21 offset:49152
    v_mfma_f32_16x16x32_bf16 v[48:51], v[120:123], v[112:115], v[48:51]
    ds_read_b128 v[180:183], v21 offset:51200
    v_mfma_f32_16x16x32_bf16 v[64:67], v[124:127], v[112:115], v[64:67]
    ds_read_b64_tr_b16 v[196:197], v30 offset:8192
    s_add_u32 m0, s65, 1024
    s_add_u32 s81, s81, 8192
    buffer_load_dwordx4 v1, s[36:39], s81 offen lds
    v_mfma_f32_16x16x32_bf16 v[80:83], v[112:115], v[128:131], v[80:83]
    ds_read_b64_tr_b16 v[198:199], v30 offset:8704
    v_mfma_f32_16x16x32_bf16 v[52:55], v[120:123], v[116:119], v[52:55]
    ds_read_b128 v[184:187], v21 offset:53248
    ds_read_b128 v[188:191], v21 offset:55296
    v_mfma_f32_16x16x32_bf16 v[68:71], v[124:127], v[116:119], v[68:71]
    v_readlane_b32 s80, v249, 4
    s_add_u32 m0, s65, 2048
    s_bitcmp1_b32 s80, 0
    s_cselect_b32 s36, s8, s16
    s_cselect_b32 s37, s9, s17
    s_and_b32 s81, s80, -2
    buffer_load_dwordx4 v1, s[36:39], s81 offen lds
    ds_read_b64_tr_b16 v[200:201], v30 offset:16384
    v_mfma_f32_16x16x32_bf16 v[84:87], v[116:119], v[128:131], v[84:87]
    ds_read_b64_tr_b16 v[202:203], v30 offset:16896
    v_mfma_f32_16x16x32_bf16 v[88:91], v[136:139], v[132:135], v[88:91]
    ds_read_b128 v[204:207], v23 offset:49152
    s_add_u32 m0, s65, 3072
    s_add_u32 s81, s81, 8192
    buffer_load_dwordx4 v1, s[36:39], s81 offen lds
    v_mfma_f32_16x16x32_bf16 v[40:43], v[156:159], v[140:143], v[40:43]
    ds_read_b128 v[208:211], v32 offset:896
    v_mfma_f32_16x16x32_bf16 v[56:59], v[160:163], v[140:143], v[56:59]
    ds_read_b64_tr_b16 v[228:229], v30 offset:4096
    ds_read_b64_tr_b16 v[230:231], v30 offset:4608
    v_mfma_f32_16x16x32_bf16 v[72:75], v[140:143], v[164:167], v[72:75]
    v_readlane_b32 s80, v249, 5
    s_add_u32 m0, s65, 4096
    s_bitcmp1_b32 s80, 0
    s_cselect_b32 s36, s8, s16
    s_cselect_b32 s37, s9, s17
    s_and_b32 s81, s80, -2
    buffer_load_dwordx4 v1, s[36:39], s81 offen lds
    v_mfma_f32_16x16x32_bf16 v[44:47], v[156:159], v[144:147], v[44:47]
    ds_read_b128 v[212:215], v22 offset:49152
    s_waitcnt lgkmcnt(6)
    ds_read_b128 v[216:219], v22 offset:51200
    v_mfma_f32_16x16x32_bf16 v[60:63], v[160:163], v[144:147], v[60:63]
    ds_read_b64_tr_b16 v[232:233], v30 offset:12288
    s_add_u32 m0, s65, 5120
    s_add_u32 s81, s81, 8192
    buffer_load_dwordx4 v1, s[36:39], s81 offen lds
    v_mfma_f32_16x16x32_bf16 v[76:79], v[144:147], v[164:167], v[76:79]
    ds_read_b64_tr_b16 v[234:235], v30 offset:12800
    v_mfma_f32_16x16x32_bf16 v[48:51], v[156:159], v[148:151], v[48:51]
    ds_read_b128 v[220:223], v22 offset:53248
    ds_read_b128 v[224:227], v22 offset:55296
    v_mfma_f32_16x16x32_bf16 v[64:67], v[160:163], v[148:151], v[64:67]
    ds_read_b64_tr_b16 v[236:237], v30 offset:20480
    v_mfma_f32_16x16x32_bf16 v[80:83], v[148:151], v[164:167], v[80:83]
    ds_read_b64_tr_b16 v[238:239], v30 offset:20992
    ds_read_b128 v[240:243], v24 offset:49152
    v_mfma_f32_16x16x32_bf16 v[52:55], v[156:159], v[152:155], v[52:55]
    ds_read_b128 v[244:247], v32 offset:960
    v_mfma_f32_16x16x32_bf16 v[68:71], v[160:163], v[152:155], v[68:71]
    v_mfma_f32_16x16x32_bf16 v[84:87], v[152:155], v[164:167], v[84:87]
    v_mfma_f32_16x16x32_bf16 v[88:91], v[172:175], v[168:171], v[88:91]
    s_waitcnt lgkmcnt(12)
    v_mfma_f32_16x16x32_bf16 v[40:43], v[192:195], v[176:179], v[40:43]
    v_mfma_f32_16x16x32_bf16 v[56:59], v[196:199], v[176:179], v[56:59]
    v_mfma_f32_16x16x32_bf16 v[72:75], v[176:179], v[200:203], v[72:75]
    v_mfma_f32_16x16x32_bf16 v[44:47], v[192:195], v[180:183], v[44:47]
    s_waitcnt lgkmcnt(0)
    s_barrier
    v_mfma_f32_16x16x32_bf16 v[60:63], v[196:199], v[180:183], v[60:63]
    v_readlane_b32 s80, v249, 6
    s_add_u32 m0, s65, 49152
    s_bitcmp1_b32 s80, 0
    s_cselect_b32 s36, s8, s16
    s_cselect_b32 s37, s9, s17
    s_and_b32 s81, s80, -2
    buffer_load_dwordx4 v1, s[36:39], s81 offen lds
    v_mfma_f32_16x16x32_bf16 v[76:79], v[180:183], v[200:203], v[76:79]
    v_mfma_f32_16x16x32_bf16 v[48:51], v[192:195], v[184:187], v[48:51]
    v_mfma_f32_16x16x32_bf16 v[64:67], v[196:199], v[184:187], v[64:67]
    s_add_u32 m0, s65, 50176
    s_add_u32 s81, s81, 8192
    buffer_load_dwordx4 v1, s[36:39], s81 offen lds
    v_mfma_f32_16x16x32_bf16 v[80:83], v[184:187], v[200:203], v[80:83]
    v_mfma_f32_16x16x32_bf16 v[52:55], v[192:195], v[188:191], v[52:55]
    v_mfma_f32_16x16x32_bf16 v[68:71], v[196:199], v[188:191], v[68:71]
    v_readlane_b32 s80, v249, 7
    s_add_u32 m0, s65, 51200
    s_bitcmp1_b32 s80, 0
    s_cselect_b32 s36, s8, s16
    s_cselect_b32 s37, s9, s17
    s_and_b32 s81, s80, -2
    buffer_load_dwordx4 v1, s[36:39], s81 offen lds
    v_mfma_f32_16x16x32_bf16 v[84:87], v[188:191], v[200:203], v[84:87]
    v_mfma_f32_16x16x32_bf16 v[88:91], v[208:211], v[204:207], v[88:91]
    v_mfma_f32_16x16x32_bf16 v[40:43], v[228:231], v[212:215], v[40:43]
    s_add_u32 m0, s65, 52224
    s_add_u32 s81, s81, 8192
    buffer_load_dwordx4 v1, s[36:39], s81 offen lds
    v_mfma_f32_16x16x32_bf16 v[56:59], v[232:235], v[212:215], v[56:59]
    v_mfma_f32_16x16x32_bf16 v[72:75], v[212:215], v[236:239], v[72:75]
    v_mfma_f32_16x16x32_bf16 v[44:47], v[228:231], v[216:219], v[44:47]
    v_readlane_b32 s80, v249, 8
    s_add_u32 m0, s65, 53248
    s_bitcmp1_b32 s80, 0
    s_cselect_b32 s36, s8, s16
    s_cselect_b32 s37, s9, s17
    s_and_b32 s81, s80, -2
    buffer_load_dwordx4 v1, s[36:39], s81 offen lds
    v_mfma_f32_16x16x32_bf16 v[60:63], v[232:235], v[216:219], v[60:63]
    v_mfma_f32_16x16x32_bf16 v[76:79], v[216:219], v[236:239], v[76:79]
    v_mfma_f32_16x16x32_bf16 v[48:51], v[228:231], v[220:223], v[48:51]
    s_add_u32 m0, s65, 54272
    s_add_u32 s81, s81, 8192
    buffer_load_dwordx4 v1, s[36:39], s81 offen lds
    v_mfma_f32_16x16x32_bf16 v[64:67], v[232:235], v[220:223], v[64:67]
    v_mfma_f32_16x16x32_bf16 v[80:83], v[220:223], v[236:239], v[80:83]
    v_mfma_f32_16x16x32_bf16 v[52:55], v[228:231], v[224:227], v[52:55]
    v_mfma_f32_16x16x32_bf16 v[68:71], v[232:235], v[224:227], v[68:71]
    v_mfma_f32_16x16x32_bf16 v[84:87], v[224:227], v[236:239], v[84:87]
    v_mfma_f32_16x16x32_bf16 v[88:91], v[244:247], v[240:243], v[88:91]
    s_nop 7
    s_nop 3
    s_add_u32 s78, s64, 149504
    v_lshl_add_u32 v39, v0, 4, s78
    v_mul_f32 v88, 0x3fb8aa3b, v88
    s_mov_b32 s77, 0x42800000
    v_med3_f32 v88, v88, s77, -s77
    v_cvt_pk_bf16_f32 v24, v68, v69
    v_cvt_pk_bf16_f32 v25, v70, v71
    v_exp_f32 v88, v88
    v_cvt_pk_bf16_f32 v34, v84, v85
    v_cvt_pk_bf16_f32 v35, v86, v87
    s_lshl_b32 s78, s3, 6
    s_add_u32 s78, s78, 157952
    v_lshl_add_u32 v89, v0, 2, s78
    s_waitcnt lgkmcnt(8)
    ds_write_b64 v39, v[24:25]
    ds_write_b64 v39, v[34:35] offset:8
    s_mov_b64 exec, 0xffff
    ds_write_b32 v89, v88
    s_mov_b64 exec, -1
    v_cvt_pk_bf16_f32 v8, v40, v41
    v_cvt_pk_bf16_f32 v9, v42, v43
    v_cvt_pk_bf16_f32 v10, v44, v45
    v_cvt_pk_bf16_f32 v11, v46, v47
    v_cvt_pk_bf16_f32 v12, v48, v49
    v_cvt_pk_bf16_f32 v13, v50, v51
    v_cvt_pk_bf16_f32 v14, v52, v53
    v_cvt_pk_bf16_f32 v15, v54, v55
    v_cvt_pk_bf16_f32 v18, v56, v57
    v_cvt_pk_bf16_f32 v28, v72, v73
    v_cvt_pk_bf16_f32 v19, v58, v59
    v_cvt_pk_bf16_f32 v29, v74, v75
    v_cvt_pk_bf16_f32 v20, v60, v61
    v_cvt_pk_bf16_f32 v30, v76, v77
    v_cvt_pk_bf16_f32 v21, v62, v63
    v_cvt_pk_bf16_f32 v31, v78, v79
    v_cvt_pk_bf16_f32 v22, v64, v65
    v_cvt_pk_bf16_f32 v32, v80, v81
    v_cvt_pk_bf16_f32 v23, v66, v67
    v_cvt_pk_bf16_f32 v33, v82, v83
    s_lshl_b32 s78, s72, 10
    s_add_u32 s78, s78, 149504
    v_lshl_add_u32 v39, v0, 4, s78
    s_and_b32 s78, s3, 4
    s_lshl_b32 s78, s78, 6
    s_add_u32 s78, s78, 157952
    v_and_b32 v89, 15, v0
    v_lshl_add_u32 v89, v89, 2, s78
    s_waitcnt lgkmcnt(0)
    s_barrier
    ds_read_b64 v[16:17], v39
    ds_read_b64 v[26:27], v39 offset:8
    ds_read_b32 v72, v89 offset:0
    ds_read_b32 v73, v89 offset:64
    ds_read_b32 v74, v89 offset:128
    ds_read_b32 v75, v89 offset:192
    s_waitcnt lgkmcnt(0)
    v_mfma_f32_16x16x16_bf16 v[40:43], v[18:19], v[8:9], v[92:95]
    v_mfma_f32_16x16x16_bf16 v[44:47], v[20:21], v[10:11], v[92:95]
    v_mfma_f32_16x16x16_bf16 v[48:51], v[22:23], v[12:13], v[92:95]
    v_mfma_f32_16x16x16_bf16 v[52:55], v[24:25], v[14:15], v[92:95]
    v_mfma_f32_16x16x16_bf16 v[60:63], v[18:19], v[10:11], v[96:99]
    v_mfma_f32_16x16x16_bf16 v[64:67], v[20:21], v[12:13], v[96:99]
    v_mfma_f32_16x16x16_bf16 v[68:71], v[22:23], v[14:15], v[96:99]
    v_mfma_f32_16x16x16_bf16 v[56:59], v[16:17], v[8:9], v[100:103]
    s_nop 4
    v_max_f32 v44, v44, v60
    v_max_f32 v45, v45, v61
    v_max_f32 v46, v46, v62
    v_max_f32 v47, v47, v63
    v_max_f32 v48, v48, v64
    v_max_f32 v49, v49, v65
    v_max_f32 v50, v50, v66
    v_max_f32 v51, v51, v67
    v_max_f32 v52, v52, v68
    v_max_f32 v53, v53, v69
    v_max_f32 v54, v54, v70
    v_max_f32 v55, v55, v71
    v_max_f32 v40, v40, v56
    v_max_f32 v41, v41, v57
    v_max_f32 v42, v42, v58
    v_max_f32 v43, v43, v59
    v_max3_f32 v76, v40, v41, v42
    v_max3_f32 v77, v44, v45, v46
    v_max3_f32 v78, v48, v49, v50
    v_max3_f32 v79, v52, v53, v54
    v_max_f32 v76, v76, v43
    v_max_f32 v77, v77, v47
    v_max_f32 v78, v78, v51
    v_max_f32 v79, v79, v55
    s_mov_b32 s78, 0x3eb8aa3b
    s_nop 0
    v_permlane32_swap_b32 v76, v77
    v_permlane32_swap_b32 v78, v79
    v_max_f32 v76, v76, v77
    v_max_f32 v78, v78, v79
    s_nop 1
    v_permlane16_swap_b32 v76, v78
    v_max_f32 v76, v76, v78
    v_mul_f32 v76, s78, v76
    v_mov_b32 v78, v76
    s_nop 1
    v_permlane16_swap_b32 v76, v78
    v_mov_b32 v77, v76
    v_mov_b32 v79, v78
    s_nop 1
    v_permlane32_swap_b32 v76, v77
    v_permlane32_swap_b32 v78, v79
    s_waitcnt lgkmcnt(0)
    v_fma_f32 v40, v40, s78, -v76
    v_fma_f32 v41, v41, s78, -v76
    v_fma_f32 v42, v42, s78, -v76
    v_fma_f32 v43, v43, s78, -v76
    v_fma_f32 v44, v44, s78, -v77
    v_fma_f32 v45, v45, s78, -v77
    v_fma_f32 v46, v46, s78, -v77
    v_fma_f32 v47, v47, s78, -v77
    v_fma_f32 v48, v48, s78, -v78
    v_fma_f32 v49, v49, s78, -v78
    v_fma_f32 v50, v50, s78, -v78
    v_fma_f32 v51, v51, s78, -v78
    v_fma_f32 v52, v52, s78, -v79
    v_fma_f32 v53, v53, s78, -v79
    v_fma_f32 v54, v54, s78, -v79
    v_fma_f32 v55, v55, s78, -v79
    v_exp_f32 v40, v40
    v_exp_f32 v41, v41
    v_exp_f32 v42, v42
    v_exp_f32 v43, v43
    v_exp_f32 v44, v44
    v_exp_f32 v45, v45
    v_exp_f32 v46, v46
    v_exp_f32 v47, v47
    v_exp_f32 v48, v48
    v_exp_f32 v49, v49
    v_exp_f32 v50, v50
    v_exp_f32 v51, v51
    v_exp_f32 v52, v52
    v_exp_f32 v53, v53
    v_exp_f32 v54, v54
    v_exp_f32 v55, v55
    v_mov_b32 v80, 0x3f803f80
    v_mov_b32 v81, 0x3f803f80
    v_cvt_pk_bf16_f32 v8, v40, v41
    v_cvt_pk_bf16_f32 v9, v42, v43
    v_cvt_pk_bf16_f32 v10, v44, v45
    v_cvt_pk_bf16_f32 v11, v46, v47
    v_cvt_pk_bf16_f32 v12, v48, v49
    v_cvt_pk_bf16_f32 v13, v50, v51
    v_cvt_pk_bf16_f32 v14, v52, v53
    v_cvt_pk_bf16_f32 v15, v54, v55
    v_and_b32 v58, v8, v36
    v_xor_b32 v56, v8, v58
    v_and_b32 v59, v9, v37
    v_xor_b32 v57, v9, v59
    v_and_b32 v62, v10, v36
    v_xor_b32 v60, v10, v62
    v_and_b32 v63, v11, v37
    v_xor_b32 v61, v11, v63
    v_and_b32 v66, v12, v36
    v_xor_b32 v64, v12, v66
    v_and_b32 v67, v13, v37
    v_xor_b32 v65, v13, v67
    v_and_b32 v70, v14, v36
    v_xor_b32 v68, v14, v70
    v_and_b32 v71, v15, v37
    v_xor_b32 v69, v15, v71
    v_mfma_f32_16x16x16_bf16 v[92:95], v[80:81], v[8:9], 0
    v_mfma_f32_16x16x16_bf16 v[96:99], v[80:81], v[10:11], 0
    v_mfma_f32_16x16x16_bf16 v[100:103], v[80:81], v[12:13], 0
    v_mfma_f32_16x16x16_bf16 v[84:87], v[80:81], v[14:15], 0
    v_mfma_f32_16x16x32_bf16 v[40:43], v[26:29], v[56:59], 0
    v_mfma_f32_16x16x32_bf16 v[44:47], v[28:31], v[60:63], 0
    v_mfma_f32_16x16x32_bf16 v[48:51], v[30:33], v[64:67], 0
    v_mfma_f32_16x16x32_bf16 v[52:55], v[32:35], v[68:71], 0
    s_mul_i32 s78, s60, 7
    s_lshr_b32 s79, s3, 2
    s_lshl_b32 s79, s79, 2
    s_add_u32 s78, s78, s79
    v_bfe_u32 v36, v0, 4, 1
    v_add_u32 v37, s78, v36
    v_lshrrev_b32 v38, 1, v37
    v_and_b32 v37, 1, v37
    s_mov_b32 s78, 147456
    v_mul_lo_u32 v38, v38, s78
    v_and_b32 v39, 0x2f, v0
    v_lshl_or_b32 v39, v37, 4, v39
    v_lshl_add_u32 v38, v39, 4, v38
    s_mul_i32 s78, s56, 4608
    s_lshl_b32 s79, s59, 2
    s_add_u32 s78, s78, s79
    s_and_b32 s79, s3, 3
    s_add_u32 s78, s78, s79
    s_lshl_b32 s78, s78, 10
    v_add_u32 v38, s78, v38
    v_add_u32 v39, 147456, v38
    s_cmp_lt_u32 s3, 4
    s_cselect_b32 s78, s60, 0
    s_cmp_lg_u32 s78, 0
    s_cselect_b32 s78, 2147483648, 0
    v_subrev_u32 v36, 1, v36
    v_and_b32 v36, s78, v36
    v_or_b32 v38, v38, v36
    v_rcp_f32 v76, v92
    v_rcp_f32 v77, v96
    v_rcp_f32 v78, v100
    v_rcp_f32 v79, v84
    v_mul_f32 v76, v76, v72
    v_mul_f32 v77, v77, v73
    v_mul_f32 v78, v78, v74
    v_mul_f32 v79, v79, v75
    v_mul_f32 v40, v40, v76
    v_mul_f32 v41, v41, v76
    v_mul_f32 v42, v42, v76
    v_mul_f32 v43, v43, v76
    v_mul_f32 v44, v44, v77
    v_mul_f32 v45, v45, v77
    v_mul_f32 v46, v46, v77
    v_mul_f32 v47, v47, v77
    v_mul_f32 v48, v48, v78
    v_mul_f32 v49, v49, v78
    v_mul_f32 v50, v50, v78
    v_mul_f32 v51, v51, v78
    v_mul_f32 v52, v52, v79
    v_mul_f32 v53, v53, v79
    v_mul_f32 v54, v54, v79
    v_mul_f32 v55, v55, v79
    v_cvt_pk_bf16_f32 v8, v40, v41
    v_cvt_pk_bf16_f32 v9, v42, v43
    v_cvt_pk_bf16_f32 v10, v44, v45
    v_cvt_pk_bf16_f32 v11, v46, v47
    v_cvt_pk_bf16_f32 v12, v48, v49
    v_cvt_pk_bf16_f32 v13, v50, v51
    v_cvt_pk_bf16_f32 v14, v52, v53
    v_cvt_pk_bf16_f32 v15, v54, v55
    s_nop 1
    v_permlane16_swap_b32 v8, v10
    v_permlane16_swap_b32 v9, v11
    v_permlane16_swap_b32 v12, v14
    v_permlane16_swap_b32 v13, v15
    buffer_store_dwordx4 v[8:11], v38, s[40:43], 0 offen sc1
    buffer_store_dwordx4 v[12:15], v39, s[40:43], 0 offen sc1
    s_lshl_b32 s78, s56, 10
    s_add_u32 s78, s78, s61
    s_lshl_b32 s79, s3, 4
    s_add_u32 s78, s78, s79
    s_lshl_b32 s78, s78, 2
    s_add_u32 s78, s78, 9437184
    s_cmp_eq_u32 s3, 0
    s_cselect_b32 s79, s60, 0
    s_or_b32 s79, s79, s59
    s_cbranch_scc1 L_nog
    v_lshl_add_u32 v36, v0, 2, s78
    s_mov_b64 exec, 0xffff
    buffer_store_dword v88, v36, s[40:43], 0 offen sc1
    s_mov_b64 exec, -1
L_nog:
    v_mov_b32 v7, 1
    s_waitcnt vmcnt(0)
    s_mov_b64 exec, 1
    buffer_store_dword v7, off, s[40:43], s71 sc1
    s_mov_b64 exec, -1
    s_cmp_eq_u32 s70, 9
    s_cbranch_scc1 L_sw_15
L_sw_14:
    ds_read_b64_tr_b16 v[104:105], v4 offset:32768
    ds_read_b64_tr_b16 v[106:107], v4 offset:33280
    ds_read_b64_tr_b16 v[108:109], v5 offset:32768
    ds_read_b64_tr_b16 v[110:111], v5 offset:33280
    ds_read_b64_tr_b16 v[112:113], v4 offset:34816
    ds_read_b64_tr_b16 v[114:115], v4 offset:35328
    ds_read_b64_tr_b16 v[116:117], v5 offset:34816
    ds_read_b64_tr_b16 v[118:119], v5 offset:35328
    ds_read_b64_tr_b16 v[120:121], v4 offset:36864
    ds_read_b64_tr_b16 v[122:123], v4 offset:37376
    ds_read_b64_tr_b16 v[124:125], v5 offset:36864
    ds_read_b64_tr_b16 v[126:127], v5 offset:37376
    s_branch L_sw_13
L_sw_15:
    ds_read_b64_tr_b16 v[176:177], v4 offset:32768
    ds_read_b64_tr_b16 v[178:179], v4 offset:33280
    ds_read_b64_tr_b16 v[180:181], v5 offset:32768
    ds_read_b64_tr_b16 v[182:183], v5 offset:33280
    ds_read_b64_tr_b16 v[184:185], v4 offset:34816
    ds_read_b64_tr_b16 v[186:187], v4 offset:35328
    ds_read_b64_tr_b16 v[188:189], v5 offset:34816
    ds_read_b64_tr_b16 v[190:191], v5 offset:35328
    ds_read_b64_tr_b16 v[192:193], v4 offset:36864
    ds_read_b64_tr_b16 v[194:195], v4 offset:37376
    ds_read_b64_tr_b16 v[196:197], v5 offset:36864
    ds_read_b64_tr_b16 v[198:199], v5 offset:37376
L_sw_13:
    s_waitcnt lgkmcnt(0)
    v_readlane_b32 s80, v249, 9
    s_add_u32 m0, s65, 98304
    s_bitcmp1_b32 s80, 0
    s_cselect_b32 s36, s8, s16
    s_cselect_b32 s37, s9, s17
    s_and_b32 s81, s80, -2
    buffer_load_dwordx4 v1, s[36:39], s81 offen lds
    s_add_u32 m0, s65, 99328
    s_add_u32 s81, s81, 8192
    buffer_load_dwordx4 v1, s[36:39], s81 offen lds
    v_readlane_b32 s80, v249, 10
    s_add_u32 m0, s65, 100352
    s_bitcmp1_b32 s80, 0
    s_cselect_b32 s36, s8, s16
    s_cselect_b32 s37, s9, s17
    s_and_b32 s81, s80, -2
    buffer_load_dwordx4 v1, s[36:39], s81 offen lds
    s_add_u32 m0, s65, 101376
    s_add_u32 s81, s81, 8192
    buffer_load_dwordx4 v1, s[36:39], s81 offen lds
    v_readlane_b32 s80, v249, 11
    s_add_u32 m0, s65, 102400
    s_bitcmp1_b32 s80, 0
    s_cselect_b32 s36, s8, s16
    s_cselect_b32 s37, s9, s17
    s_and_b32 s81, s80, -2
    buffer_load_dwordx4 v1, s[36:39], s81 offen lds
    s_add_u32 m0, s65, 103424
    s_add_u32 s81, s81, 8192
    buffer_load_dwordx4 v1, s[36:39], s81 offen lds
    s_cmp_eq_u32 s70, 9
    s_cbranch_scc1 L_sw_18
L_sw_17:
    ds_read_b64_tr_b16 v[128:129], v2 offset:0
    ds_read_b64_tr_b16 v[130:131], v2 offset:512
    ds_read_b64_tr_b16 v[132:133], v3 offset:0
    ds_read_b64_tr_b16 v[134:135], v3 offset:512
    ds_read_b64_tr_b16 v[136:137], v2 offset:2048
    ds_read_b64_tr_b16 v[138:139], v2 offset:2560
    ds_read_b64_tr_b16 v[140:141], v3 offset:2048
    ds_read_b64_tr_b16 v[142:143], v3 offset:2560
    ds_read_b64_tr_b16 v[144:145], v2 offset:4096
    ds_read_b64_tr_b16 v[146:147], v2 offset:4608
    ds_read_b64_tr_b16 v[148:149], v3 offset:4096
    ds_read_b64_tr_b16 v[150:151], v3 offset:4608
    s_branch L_sw_16
L_sw_18:
    ds_read_b64_tr_b16 v[200:201], v2 offset:0
    ds_read_b64_tr_b16 v[202:203], v2 offset:512
    ds_read_b64_tr_b16 v[204:205], v3 offset:0
    ds_read_b64_tr_b16 v[206:207], v3 offset:512
    ds_read_b64_tr_b16 v[208:209], v2 offset:2048
    ds_read_b64_tr_b16 v[210:211], v2 offset:2560
    ds_read_b64_tr_b16 v[212:213], v3 offset:2048
    ds_read_b64_tr_b16 v[214:215], v3 offset:2560
    ds_read_b64_tr_b16 v[216:217], v2 offset:4096
    ds_read_b64_tr_b16 v[218:219], v2 offset:4608
    ds_read_b64_tr_b16 v[220:221], v3 offset:4096
    ds_read_b64_tr_b16 v[222:223], v3 offset:4608
L_sw_16:
    s_waitcnt lgkmcnt(0)
    v_readlane_b32 s80, v249, 12
    s_add_u32 m0, s65, 0
    s_bitcmp1_b32 s80, 0
    s_cselect_b32 s36, s8, s16
    s_cselect_b32 s37, s9, s17
    s_and_b32 s81, s80, -2
    buffer_load_dwordx4 v1, s[36:39], s81 offen lds
    s_add_u32 m0, s65, 1024
    s_add_u32 s81, s81, 8192
    buffer_load_dwordx4 v1, s[36:39], s81 offen lds
    v_readlane_b32 s80, v249, 13
    s_add_u32 m0, s65, 2048
    s_bitcmp1_b32 s80, 0
    s_cselect_b32 s36, s8, s16
    s_cselect_b32 s37, s9, s17
    s_and_b32 s81, s80, -2
    buffer_load_dwordx4 v1, s[36:39], s81 offen lds
    s_add_u32 m0, s65, 3072
    s_add_u32 s81, s81, 8192
    buffer_load_dwordx4 v1, s[36:39], s81 offen lds
    v_readlane_b32 s80, v249, 14
    s_add_u32 m0, s65, 4096
    s_bitcmp1_b32 s80, 0
    s_cselect_b32 s36, s8, s16
    s_cselect_b32 s37, s9, s17
    s_and_b32 s81, s80, -2
    buffer_load_dwordx4 v1, s[36:39], s81 offen lds
    s_add_u32 m0, s65, 5120
    s_add_u32 s81, s81, 8192
    buffer_load_dwordx4 v1, s[36:39], s81 offen lds
    s_cmp_eq_u32 s70, 9
    s_cbranch_scc1 L_sw_21
L_sw_20:
    ds_read_b64_tr_b16 v[152:153], v2 offset:49152
    ds_read_b64_tr_b16 v[154:155], v2 offset:49664
    ds_read_b64_tr_b16 v[156:157], v3 offset:49152
    ds_read_b64_tr_b16 v[158:159], v3 offset:49664
    ds_read_b64_tr_b16 v[160:161], v2 offset:51200
    ds_read_b64_tr_b16 v[162:163], v2 offset:51712
    ds_read_b64_tr_b16 v[164:165], v3 offset:51200
    ds_read_b64_tr_b16 v[166:167], v3 offset:51712
    ds_read_b64_tr_b16 v[168:169], v2 offset:53248
    ds_read_b64_tr_b16 v[170:171], v2 offset:53760
    ds_read_b64_tr_b16 v[172:173], v3 offset:53248
    ds_read_b64_tr_b16 v[174:175], v3 offset:53760
    s_branch L_sw_19
L_sw_21:
    ds_read_b64_tr_b16 v[224:225], v2 offset:49152
    ds_read_b64_tr_b16 v[226:227], v2 offset:49664
    ds_read_b64_tr_b16 v[228:229], v3 offset:49152
    ds_read_b64_tr_b16 v[230:231], v3 offset:49664
    ds_read_b64_tr_b16 v[232:233], v2 offset:51200
    ds_read_b64_tr_b16 v[234:235], v2 offset:51712
    ds_read_b64_tr_b16 v[236:237], v3 offset:51200
    ds_read_b64_tr_b16 v[238:239], v3 offset:51712
    ds_read_b64_tr_b16 v[240:241], v2 offset:53248
    ds_read_b64_tr_b16 v[242:243], v2 offset:53760
    ds_read_b64_tr_b16 v[244:245], v3 offset:53248
    ds_read_b64_tr_b16 v[246:247], v3 offset:53760
L_sw_19:
    s_waitcnt lgkmcnt(0)
    v_readlane_b32 s80, v249, 15
    s_add_u32 m0, s65, 49152
    s_bitcmp1_b32 s80, 0
    s_cselect_b32 s36, s8, s16
    s_cselect_b32 s37, s9, s17
    s_and_b32 s81, s80, -2
    buffer_load_dwordx4 v1, s[36:39], s81 offen lds
    s_add_u32 m0, s65, 50176
    s_add_u32 s81, s81, 8192
    buffer_load_dwordx4 v1, s[36:39], s81 offen lds
    v_readlane_b32 s80, v249, 16
    s_add_u32 m0, s65, 51200
    s_bitcmp1_b32 s80, 0
    s_cselect_b32 s36, s8, s16
    s_cselect_b32 s37, s9, s17
    s_and_b32 s81, s80, -2
    buffer_load_dwordx4 v1, s[36:39], s81 offen lds
    s_add_u32 m0, s65, 52224
    s_add_u32 s81, s81, 8192
    buffer_load_dwordx4 v1, s[36:39], s81 offen lds
    v_readlane_b32 s80, v249, 17
    s_add_u32 m0, s65, 53248
    s_bitcmp1_b32 s80, 0
    s_cselect_b32 s36, s8, s16
    s_cselect_b32 s37, s9, s17
    s_and_b32 s81, s80, -2
    buffer_load_dwordx4 v1, s[36:39], s81 offen lds
    s_add_u32 m0, s65, 54272
    s_add_u32 s81, s81, 8192
    buffer_load_dwordx4 v1, s[36:39], s81 offen lds
    s_cmp_ge_u32 s3, 4
    s_cbranch_scc1 L_p2_g1
L_p2_g0:
    s_setprio 0
L_pa0:
    buffer_load_dword v7, v250, s[40:43], 0 offen sc1
    s_add_u32 s66, s66, 1
    s_cmp_ge_u32 s66, 262144
    s_cbranch_scc1 L_pa0_d
L_pa0_c:
    s_waitcnt vmcnt(0)
    v_cmp_ne_u32 vcc, 1, v7
    s_cbranch_vccnz L_pa0
L_pa0_d:
    s_cmp_lg_u32 s3, 0
    s_cbranch_scc1 L_ng2
    s_lshl_b32 s77, s56, 10
    s_add_u32 s77, s77, s67
    s_lshl_b32 s77, s77, 2
    s_add_u32 s77, s77, 9437184
    v_lshlrev_b32 v255, 2, v0
    buffer_load_dword v255, v255, s[40:43], s77 offen sc1
L_ng2:
    v_readlane_b32 s77, v248, 0
    s_mov_b32 s74, s77
    buffer_load_dwordx4 v[8:11], v252, s[40:43], s74 offen sc1
    buffer_load_dwordx4 v[12:15], v253, s[40:43], s74 offen sc1
    v_readlane_b32 s77, v248, 1
    s_mov_b32 s74, s77
    buffer_load_dwordx4 v[16:19], v252, s[40:43], s74 offen sc1
    buffer_load_dwordx4 v[20:23], v253, s[40:43], s74 offen sc1
    v_readlane_b32 s77, v248, 2
    s_mov_b32 s74, s77
    buffer_load_dwordx4 v[24:27], v252, s[40:43], s74 offen sc1
    buffer_load_dwordx4 v[28:31], v253, s[40:43], s74 offen sc1
    v_readlane_b32 s77, v248, 3
    s_mov_b32 s74, s77
    buffer_load_dwordx4 v[32:35], v252, s[40:43], s74 offen sc1
    buffer_load_dwordx4 v[36:39], v253, s[40:43], s74 offen sc1
    buffer_load_dword v7, v251, s[40:43], 0 offen sc1
    s_cmp_eq_u32 s70, 9
    s_cbranch_scc1 L_sw_24
L_sw_23:
    ds_read_b64_tr_b16 v[176:177], v4 offset:32768
    ds_read_b64_tr_b16 v[178:179], v4 offset:33280
    ds_read_b64_tr_b16 v[180:181], v5 offset:32768
    ds_read_b64_tr_b16 v[182:183], v5 offset:33280
    ds_read_b64_tr_b16 v[184:185], v4 offset:34816
    ds_read_b64_tr_b16 v[186:187], v4 offset:35328
    ds_read_b64_tr_b16 v[188:189], v5 offset:34816
    ds_read_b64_tr_b16 v[190:191], v5 offset:35328
    ds_read_b64_tr_b16 v[192:193], v4 offset:36864
    ds_read_b64_tr_b16 v[194:195], v4 offset:37376
    ds_read_b64_tr_b16 v[196:197], v5 offset:36864
    ds_read_b64_tr_b16 v[198:199], v5 offset:37376
    s_branch L_sw_22
L_sw_24:
    ds_read_b64_tr_b16 v[104:105], v4 offset:32768
    ds_read_b64_tr_b16 v[106:107], v4 offset:33280
    ds_read_b64_tr_b16 v[108:109], v5 offset:32768
    ds_read_b64_tr_b16 v[110:111], v5 offset:33280
    ds_read_b64_tr_b16 v[112:113], v4 offset:34816
    ds_read_b64_tr_b16 v[114:115], v4 offset:35328
    ds_read_b64_tr_b16 v[116:117], v5 offset:34816
    ds_read_b64_tr_b16 v[118:119], v5 offset:35328
    ds_read_b64_tr_b16 v[120:121], v4 offset:36864
    ds_read_b64_tr_b16 v[122:123], v4 offset:37376
    ds_read_b64_tr_b16 v[124:125], v5 offset:36864
    ds_read_b64_tr_b16 v[126:127], v5 offset:37376
L_sw_22:
    s_waitcnt lgkmcnt(3)
    s_cmp_eq_u32 s70, 9
    s_cbranch_scc1 L_sw_27
L_sw_26:
    ds_read_b64_tr_b16 v[200:201], v2 offset:0
    ds_read_b64_tr_b16 v[202:203], v2 offset:512
    ds_read_b64_tr_b16 v[204:205], v3 offset:0
    ds_read_b64_tr_b16 v[206:207], v3 offset:512
    ds_read_b64_tr_b16 v[208:209], v2 offset:2048
    ds_read_b64_tr_b16 v[210:211], v2 offset:2560
    ds_read_b64_tr_b16 v[212:213], v3 offset:2048
    ds_read_b64_tr_b16 v[214:215], v3 offset:2560
    ds_read_b64_tr_b16 v[216:217], v2 offset:4096
    ds_read_b64_tr_b16 v[218:219], v2 offset:4608
    ds_read_b64_tr_b16 v[220:221], v3 offset:4096
    ds_read_b64_tr_b16 v[222:223], v3 offset:4608
    s_branch L_sw_25
L_sw_27:
    ds_read_b64_tr_b16 v[128:129], v2 offset:0
    ds_read_b64_tr_b16 v[130:131], v2 offset:512
    ds_read_b64_tr_b16 v[132:133], v3 offset:0
    ds_read_b64_tr_b16 v[134:135], v3 offset:512
    ds_read_b64_tr_b16 v[136:137], v2 offset:2048
    ds_read_b64_tr_b16 v[138:139], v2 offset:2560
    ds_read_b64_tr_b16 v[140:141], v3 offset:2048
    ds_read_b64_tr_b16 v[142:143], v3 offset:2560
    ds_read_b64_tr_b16 v[144:145], v2 offset:4096
    ds_read_b64_tr_b16 v[146:147], v2 offset:4608
    ds_read_b64_tr_b16 v[148:149], v3 offset:4096
    ds_read_b64_tr_b16 v[150:151], v3 offset:4608
L_sw_25:
    s_waitcnt lgkmcnt(3)
    s_cmp_eq_u32 s70, 9
    s_cbranch_scc1 L_sw_30
L_sw_29:
    ds_read_b64_tr_b16 v[224:225], v2 offset:49152
    ds_read_b64_tr_b16 v[226:227], v2 offset:49664
    ds_read_b64_tr_b16 v[228:229], v3 offset:49152
    ds_read_b64_tr_b16 v[230:231], v3 offset:49664
    ds_read_b64_tr_b16 v[232:233], v2 offset:51200
    ds_read_b64_tr_b16 v[234:235], v2 offset:51712
    ds_read_b64_tr_b16 v[236:237], v3 offset:51200
    ds_read_b64_tr_b16 v[238:239], v3 offset:51712
    ds_read_b64_tr_b16 v[240:241], v2 offset:53248
    ds_read_b64_tr_b16 v[242:243], v2 offset:53760
    ds_read_b64_tr_b16 v[244:245], v3 offset:53248
    ds_read_b64_tr_b16 v[246:247], v3 offset:53760
    s_branch L_sw_28
L_sw_30:
    ds_read_b64_tr_b16 v[152:153], v2 offset:49152
    ds_read_b64_tr_b16 v[154:155], v2 offset:49664
    ds_read_b64_tr_b16 v[156:157], v3 offset:49152
    ds_read_b64_tr_b16 v[158:159], v3 offset:49664
    ds_read_b64_tr_b16 v[160:161], v2 offset:51200
    ds_read_b64_tr_b16 v[162:163], v2 offset:51712
    ds_read_b64_tr_b16 v[164:165], v3 offset:51200
    ds_read_b64_tr_b16 v[166:167], v3 offset:51712
    ds_read_b64_tr_b16 v[168:169], v2 offset:53248
    ds_read_b64_tr_b16 v[170:171], v2 offset:53760
    ds_read_b64_tr_b16 v[172:173], v3 offset:53248
    ds_read_b64_tr_b16 v[174:175], v3 offset:53760
L_sw_28:
    s_waitcnt lgkmcnt(0)
    s_mov_b32 s48, s18
    s_mov_b32 s49, s19
    s_mov_b32 s50, 1024
    s_mov_b32 s51, 0x00020000
    s_waitcnt vmcnt(7)
    v_mfma_f32_32x32x16_bf16 v[40:55], v[104:107], v[8:11], 0
    v_mfma_f32_32x32x16_bf16 v[72:87], v[108:111], v[8:11], 0
    v_mfma_f32_32x32x16_bf16 v[56:71], v[104:107], v[12:15], 0
    v_mfma_f32_32x32x16_bf16 v[88:103], v[108:111], v[12:15], 0
    v_readlane_b32 s77, v248, 4
    s_mov_b32 s74, s77
    buffer_load_dwordx4 v[8:11], v252, s[40:43], s74 offen sc1
    buffer_load_dwordx4 v[12:15], v253, s[40:43], s74 offen sc1
    v_readlane_b32 s77, v248, 5
    s_mov_b32 s74, s77
    buffer_load_dwordx4 v[104:107], v252, s[40:43], s74 offen sc1
    buffer_load_dwordx4 v[108:111], v253, s[40:43], s74 offen sc1
    s_waitcnt vmcnt(9)
    v_mfma_f32_32x32x16_bf16 v[40:55], v[112:115], v[16:19], v[40:55]
    v_mfma_f32_32x32x16_bf16 v[72:87], v[116:119], v[16:19], v[72:87]
    v_mfma_f32_32x32x16_bf16 v[56:71], v[112:115], v[20:23], v[56:71]
    v_mfma_f32_32x32x16_bf16 v[88:103], v[116:119], v[20:23], v[88:103]
    v_readlane_b32 s77, v248, 6
    s_mov_b32 s74, s77
    buffer_load_dwordx4 v[16:19], v252, s[40:43], s74 offen sc1
    buffer_load_dwordx4 v[20:23], v253, s[40:43], s74 offen sc1
    v_readlane_b32 s77, v248, 7
    s_mov_b32 s74, s77
    buffer_load_dwordx4 v[112:115], v252, s[40:43], s74 offen sc1
    buffer_load_dwordx4 v[116:119], v253, s[40:43], s74 offen sc1
    s_waitcnt vmcnt(11)
    v_mfma_f32_32x32x16_bf16 v[40:55], v[120:123], v[24:27], v[40:55]
    v_mfma_f32_32x32x16_bf16 v[72:87], v[124:127], v[24:27], v[72:87]
    v_mfma_f32_32x32x16_bf16 v[56:71], v[120:123], v[28:31], v[56:71]
    v_mfma_f32_32x32x16_bf16 v[88:103], v[124:127], v[28:31], v[88:103]
    s_waitcnt vmcnt(9)
    v_mfma_f32_32x32x16_bf16 v[40:55], v[128:131], v[32:35], v[40:55]
    v_mfma_f32_32x32x16_bf16 v[72:87], v[132:135], v[32:35], v[72:87]
    v_mfma_f32_32x32x16_bf16 v[56:71], v[128:131], v[36:39], v[56:71]
    v_mfma_f32_32x32x16_bf16 v[88:103], v[132:135], v[36:39], v[88:103]
    s_waitcnt vmcnt(8)
    v_cmp_ne_u32 vcc, 1, v7
    s_cbranch_vccnz L_slow0
    s_waitcnt vmcnt(6)
    v_mfma_f32_32x32x16_bf16 v[40:55], v[136:139], v[8:11], v[40:55]
    v_mfma_f32_32x32x16_bf16 v[72:87], v[140:143], v[8:11], v[72:87]
    v_mfma_f32_32x32x16_bf16 v[56:71], v[136:139], v[12:15], v[56:71]
    v_mfma_f32_32x32x16_bf16 v[88:103], v[140:143], v[12:15], v[88:103]
    v_readlane_b32 s77, v248, 8
    s_mov_b32 s74, s77
    buffer_load_dwordx4 v[24:27], v252, s[40:43], s74 offen sc1
    buffer_load_dwordx4 v[28:31], v253, s[40:43], s74 offen sc1
    v_readlane_b32 s77, v248, 9
    s_mov_b32 s74, s77
    buffer_load_dwordx4 v[120:123], v252, s[40:43], s74 offen sc1
    buffer_load_dwordx4 v[124:127], v253, s[40:43], s74 offen sc1
    v_readlane_b32 s77, v248, 10
    s_mov_b32 s74, s77
    buffer_load_dwordx4 v[32:35], v252, s[40:43], s74 offen sc1
    buffer_load_dwordx4 v[36:39], v253, s[40:43], s74 offen sc1
    s_waitcnt vmcnt(10)
    v_mfma_f32_32x32x16_bf16 v[40:55], v[144:147], v[104:107], v[40:55]
    v_mfma_f32_32x32x16_bf16 v[72:87], v[148:151], v[104:107], v[72:87]
    v_mfma_f32_32x32x16_bf16 v[56:71], v[144:147], v[108:111], v[56:71]
    v_mfma_f32_32x32x16_bf16 v[88:103], v[148:151], v[108:111], v[88:103]
    v_readlane_b32 s77, v248, 11
    s_mov_b32 s74, s77
    buffer_load_dwordx4 v[128:131], v252, s[40:43], s74 offen sc1
    buffer_load_dwordx4 v[132:135], v253, s[40:43], s74 offen sc1
    s_waitcnt vmcnt(10)
    v_mfma_f32_32x32x16_bf16 v[40:55], v[152:155], v[16:19], v[40:55]
    v_mfma_f32_32x32x16_bf16 v[72:87], v[156:159], v[16:19], v[72:87]
    v_mfma_f32_32x32x16_bf16 v[56:71], v[152:155], v[20:23], v[56:71]
    v_mfma_f32_32x32x16_bf16 v[88:103], v[156:159], v[20:23], v[88:103]
    v_readlane_b32 s77, v248, 12
    s_mov_b32 s74, s77
    buffer_load_dwordx4 v[8:11], v252, s[40:43], s74 offen sc1
    buffer_load_dwordx4 v[12:15], v253, s[40:43], s74 offen sc1
    s_waitcnt vmcnt(10)
    v_mfma_f32_32x32x16_bf16 v[40:55], v[160:163], v[112:115], v[40:55]
    v_mfma_f32_32x32x16_bf16 v[72:87], v[164:167], v[112:115], v[72:87]
    v_mfma_f32_32x32x16_bf16 v[56:71], v[160:163], v[116:119], v[56:71]
    v_mfma_f32_32x32x16_bf16 v[88:103], v[164:167], v[116:119], v[88:103]
    v_readlane_b32 s77, v248, 13
    s_mov_b32 s74, s77
    buffer_load_dwordx4 v[136:139], v252, s[40:43], s74 offen sc1
    buffer_load_dwordx4 v[140:143], v253, s[40:43], s74 offen sc1
    s_branch L_mrg0
L_slow0:
    buffer_load_dword v7, v251, s[40:43], 0 offen sc1
    s_waitcnt vmcnt(7)
    v_mfma_f32_32x32x16_bf16 v[40:55], v[136:139], v[8:11], v[40:55]
    v_mfma_f32_32x32x16_bf16 v[72:87], v[140:143], v[8:11], v[72:87]
    v_mfma_f32_32x32x16_bf16 v[56:71], v[136:139], v[12:15], v[56:71]
    v_mfma_f32_32x32x16_bf16 v[88:103], v[140:143], v[12:15], v[88:103]
    s_waitcnt vmcnt(5)
    v_mfma_f32_32x32x16_bf16 v[40:55], v[144:147], v[104:107], v[40:55]
    v_mfma_f32_32x32x16_bf16 v[72:87], v[148:151], v[104:107], v[72:87]
    v_mfma_f32_32x32x16_bf16 v[56:71], v[144:147], v[108:111], v[56:71]
    v_mfma_f32_32x32x16_bf16 v[88:103], v[148:151], v[108:111], v[88:103]
    s_waitcnt vmcnt(3)
    v_mfma_f32_32x32x16_bf16 v[40:55], v[152:155], v[16:19], v[40:55]
    v_mfma_f32_32x32x16_bf16 v[72:87], v[156:159], v[16:19], v[72:87]
    v_mfma_f32_32x32x16_bf16 v[56:71], v[152:155], v[20:23], v[56:71]
    v_mfma_f32_32x32x16_bf16 v[88:103], v[156:159], v[20:23], v[88:103]
    s_waitcnt vmcnt(1)
    v_mfma_f32_32x32x16_bf16 v[40:55], v[160:163], v[112:115], v[40:55]
    v_mfma_f32_32x32x16_bf16 v[72:87], v[164:167], v[112:115], v[72:87]
    v_mfma_f32_32x32x16_bf16 v[56:71], v[160:163], v[116:119], v[56:71]
    v_mfma_f32_32x32x16_bf16 v[88:103], v[164:167], v[116:119], v[88:103]
    s_branch L_pb0_c
L_pb0:
    buffer_load_dword v7, v251, s[40:43], 0 offen sc1
    s_add_u32 s66, s66, 1
    s_cmp_ge_u32 s66, 262144
    s_cbranch_scc1 L_pb0_d
L_pb0_c:
    s_waitcnt vmcnt(0)
    v_cmp_ne_u32 vcc, 1, v7
    s_cbranch_vccnz L_pb0
L_pb0_d:
    v_readlane_b32 s77, v248, 8
    s_mov_b32 s74, s77
    buffer_load_dwordx4 v[24:27], v252, s[40:43], s74 offen sc1
    buffer_load_dwordx4 v[28:31], v253, s[40:43], s74 offen sc1
    v_readlane_b32 s77, v248, 9
    s_mov_b32 s74, s77
    buffer_load_dwordx4 v[120:123], v252, s[40:43], s74 offen sc1
    buffer_load_dwordx4 v[124:127], v253, s[40:43], s74 offen sc1
    v_readlane_b32 s77, v248, 10
    s_mov_b32 s74, s77
    buffer_load_dwordx4 v[32:35], v252, s[40:43], s74 offen sc1
    buffer_load_dwordx4 v[36:39], v253, s[40:43], s74 offen sc1
    v_readlane_b32 s77, v248, 11
    s_mov_b32 s74, s77
    buffer_load_dwordx4 v[128:131], v252, s[40:43], s74 offen sc1
    buffer_load_dwordx4 v[132:135], v253, s[40:43], s74 offen sc1
    v_readlane_b32 s77, v248, 12
    s_mov_b32 s74, s77
    buffer_load_dwordx4 v[8:11], v252, s[40:43], s74 offen sc1
    buffer_load_dwordx4 v[12:15], v253, s[40:43], s74 offen sc1
    v_readlane_b32 s77, v248, 13
    s_mov_b32 s74, s77
    buffer_load_dwordx4 v[136:139], v252, s[40:43], s74 offen sc1
    buffer_load_dwordx4 v[140:143], v253, s[40:43], s74 offen sc1
L_mrg0:
    s_waitcnt vmcnt(10)
    v_mfma_f32_32x32x16_bf16 v[40:55], v[168:171], v[24:27], v[40:55]
    v_mfma_f32_32x32x16_bf16 v[72:87], v[172:175], v[24:27], v[72:87]
    v_mfma_f32_32x32x16_bf16 v[56:71], v[168:171], v[28:31], v[56:71]
    v_mfma_f32_32x32x16_bf16 v[88:103], v[172:175], v[28:31], v[88:103]
    v_readlane_b32 s77, v248, 14
    s_mov_b32 s74, s77
    buffer_load_dwordx4 v[104:107], v252, s[40:43], s74 offen sc1
    buffer_load_dwordx4 v[108:111], v253, s[40:43], s74 offen sc1
    buffer_load_dwordx4 v[2:5], v254, s[48:51], 0 offen
    s_waitcnt vmcnt(11)
    v_mfma_f32_32x32x16_bf16 v[40:55], v[176:179], v[120:123], v[40:55]
    v_mfma_f32_32x32x16_bf16 v[72:87], v[180:183], v[120:123], v[72:87]
    v_mfma_f32_32x32x16_bf16 v[56:71], v[176:179], v[124:127], v[56:71]
    v_mfma_f32_32x32x16_bf16 v[88:103], v[180:183], v[124:127], v[88:103]
    v_readlane_b32 s77, v248, 15
    s_mov_b32 s74, s77
    buffer_load_dwordx4 v[144:147], v252, s[40:43], s74 offen sc1
    buffer_load_dwordx4 v[148:151], v253, s[40:43], s74 offen sc1
    s_waitcnt vmcnt(11)
    v_mfma_f32_32x32x16_bf16 v[40:55], v[184:187], v[32:35], v[40:55]
    v_mfma_f32_32x32x16_bf16 v[72:87], v[188:191], v[32:35], v[72:87]
    v_mfma_f32_32x32x16_bf16 v[56:71], v[184:187], v[36:39], v[56:71]
    v_mfma_f32_32x32x16_bf16 v[88:103], v[188:191], v[36:39], v[88:103]
    v_readlane_b32 s77, v248, 16
    s_mov_b32 s74, s77
    buffer_load_dwordx4 v[16:19], v252, s[40:43], s74 offen sc1
    buffer_load_dwordx4 v[20:23], v253, s[40:43], s74 offen sc1
    s_waitcnt vmcnt(11)
    v_mfma_f32_32x32x16_bf16 v[40:55], v[192:195], v[128:131], v[40:55]
    v_mfma_f32_32x32x16_bf16 v[72:87], v[196:199], v[128:131], v[72:87]
    v_mfma_f32_32x32x16_bf16 v[56:71], v[192:195], v[132:135], v[56:71]
    v_mfma_f32_32x32x16_bf16 v[88:103], v[196:199], v[132:135], v[88:103]
    v_readlane_b32 s77, v248, 17
    s_mov_b32 s74, s77
    buffer_load_dwordx4 v[152:155], v252, s[40:43], s74 offen sc1
    buffer_load_dwordx4 v[156:159], v253, s[40:43], s74 offen sc1
    s_waitcnt vmcnt(11)
    v_mfma_f32_32x32x16_bf16 v[40:55], v[200:203], v[8:11], v[40:55]
    v_mfma_f32_32x32x16_bf16 v[72:87], v[204:207], v[8:11], v[72:87]
    v_mfma_f32_32x32x16_bf16 v[56:71], v[200:203], v[12:15], v[56:71]
    v_mfma_f32_32x32x16_bf16 v[88:103], v[204:207], v[12:15], v[88:103]
    s_waitcnt vmcnt(9)
    v_mfma_f32_32x32x16_bf16 v[40:55], v[208:211], v[136:139], v[40:55]
    v_mfma_f32_32x32x16_bf16 v[72:87], v[212:215], v[136:139], v[72:87]
    v_mfma_f32_32x32x16_bf16 v[56:71], v[208:211], v[140:143], v[56:71]
    v_mfma_f32_32x32x16_bf16 v[88:103], v[212:215], v[140:143], v[88:103]
    s_waitcnt vmcnt(7)
    v_mfma_f32_32x32x16_bf16 v[40:55], v[216:219], v[104:107], v[40:55]
    v_mfma_f32_32x32x16_bf16 v[72:87], v[220:223], v[104:107], v[72:87]
    v_mfma_f32_32x32x16_bf16 v[56:71], v[216:219], v[108:111], v[56:71]
    v_mfma_f32_32x32x16_bf16 v[88:103], v[220:223], v[108:111], v[88:103]
    s_waitcnt vmcnt(4)
    v_mfma_f32_32x32x16_bf16 v[40:55], v[224:227], v[144:147], v[40:55]
    v_mfma_f32_32x32x16_bf16 v[72:87], v[228:231], v[144:147], v[72:87]
    v_mfma_f32_32x32x16_bf16 v[56:71], v[224:227], v[148:151], v[56:71]
    v_mfma_f32_32x32x16_bf16 v[88:103], v[228:231], v[148:151], v[88:103]
    s_waitcnt vmcnt(2)
    v_mfma_f32_32x32x16_bf16 v[40:55], v[232:235], v[16:19], v[40:55]
    v_mfma_f32_32x32x16_bf16 v[72:87], v[236:239], v[16:19], v[72:87]
    v_mfma_f32_32x32x16_bf16 v[56:71], v[232:235], v[20:23], v[56:71]
    v_mfma_f32_32x32x16_bf16 v[88:103], v[236:239], v[20:23], v[88:103]
    s_waitcnt vmcnt(0)
    v_mfma_f32_32x32x16_bf16 v[40:55], v[240:243], v[152:155], v[40:55]
    v_mfma_f32_32x32x16_bf16 v[72:87], v[244:247], v[152:155], v[72:87]
    v_mfma_f32_32x32x16_bf16 v[56:71], v[240:243], v[156:159], v[56:71]
    v_mfma_f32_32x32x16_bf16 v[88:103], v[244:247], v[156:159], v[88:103]
    s_branch L_red
L_p2_g1:
    s_setprio 1
L_pa1:
    buffer_load_dword v7, v250, s[40:43], 0 offen sc1
    s_add_u32 s66, s66, 1
    s_cmp_ge_u32 s66, 262144
    s_cbranch_scc1 L_pa1_d
L_pa1_c:
    s_waitcnt vmcnt(0)
    v_cmp_ne_u32 vcc, 1, v7
    s_cbranch_vccnz L_pa1
L_pa1_d:
    v_readlane_b32 s77, v248, 0
    s_mov_b32 s74, s77
    buffer_load_dwordx4 v[8:11], v252, s[40:43], s74 offen sc1
    buffer_load_dwordx4 v[12:15], v253, s[40:43], s74 offen sc1
    v_readlane_b32 s77, v248, 1
    s_mov_b32 s74, s77
    buffer_load_dwordx4 v[16:19], v252, s[40:43], s74 offen sc1
    buffer_load_dwordx4 v[20:23], v253, s[40:43], s74 offen sc1
    v_readlane_b32 s77, v248, 2
    s_mov_b32 s74, s77
    buffer_load_dwordx4 v[24:27], v252, s[40:43], s74 offen sc1
    buffer_load_dwordx4 v[28:31], v253, s[40:43], s74 offen sc1
    v_readlane_b32 s77, v248, 3
    s_mov_b32 s74, s77
    buffer_load_dwordx4 v[32:35], v252, s[40:43], s74 offen sc1
    buffer_load_dwordx4 v[36:39], v253, s[40:43], s74 offen sc1
    buffer_load_dword v7, v251, s[40:43], 0 offen sc1
    s_cmp_eq_u32 s70, 9
    s_cbranch_scc1 L_sw_33
L_sw_32:
    ds_read_b64_tr_b16 v[176:177], v4 offset:32768
    ds_read_b64_tr_b16 v[178:179], v4 offset:33280
    ds_read_b64_tr_b16 v[180:181], v5 offset:32768
    ds_read_b64_tr_b16 v[182:183], v5 offset:33280
    ds_read_b64_tr_b16 v[184:185], v4 offset:34816
    ds_read_b64_tr_b16 v[186:187], v4 offset:35328
    ds_read_b64_tr_b16 v[188:189], v5 offset:34816
    ds_read_b64_tr_b16 v[190:191], v5 offset:35328
    ds_read_b64_tr_b16 v[192:193], v4 offset:36864
    ds_read_b64_tr_b16 v[194:195], v4 offset:37376
    ds_read_b64_tr_b16 v[196:197], v5 offset:36864
    ds_read_b64_tr_b16 v[198:199], v5 offset:37376
    s_branch L_sw_31
L_sw_33:
    ds_read_b64_tr_b16 v[104:105], v4 offset:32768
    ds_read_b64_tr_b16 v[106:107], v4 offset:33280
    ds_read_b64_tr_b16 v[108:109], v5 offset:32768
    ds_read_b64_tr_b16 v[110:111], v5 offset:33280
    ds_read_b64_tr_b16 v[112:113], v4 offset:34816
    ds_read_b64_tr_b16 v[114:115], v4 offset:35328
    ds_read_b64_tr_b16 v[116:117], v5 offset:34816
    ds_read_b64_tr_b16 v[118:119], v5 offset:35328
    ds_read_b64_tr_b16 v[120:121], v4 offset:36864
    ds_read_b64_tr_b16 v[122:123], v4 offset:37376
    ds_read_b64_tr_b16 v[124:125], v5 offset:36864
    ds_read_b64_tr_b16 v[126:127], v5 offset:37376
L_sw_31:
    s_waitcnt lgkmcnt(3)
    s_cmp_eq_u32 s70, 9
    s_cbranch_scc1 L_sw_36
L_sw_35:
    ds_read_b64_tr_b16 v[200:201], v2 offset:0
    ds_read_b64_tr_b16 v[202:203], v2 offset:512
    ds_read_b64_tr_b16 v[204:205], v3 offset:0
    ds_read_b64_tr_b16 v[206:207], v3 offset:512
    ds_read_b64_tr_b16 v[208:209], v2 offset:2048
    ds_read_b64_tr_b16 v[210:211], v2 offset:2560
    ds_read_b64_tr_b16 v[212:213], v3 offset:2048
    ds_read_b64_tr_b16 v[214:215], v3 offset:2560
    ds_read_b64_tr_b16 v[216:217], v2 offset:4096
    ds_read_b64_tr_b16 v[218:219], v2 offset:4608
    ds_read_b64_tr_b16 v[220:221], v3 offset:4096
    ds_read_b64_tr_b16 v[222:223], v3 offset:4608
    s_branch L_sw_34
L_sw_36:
    ds_read_b64_tr_b16 v[128:129], v2 offset:0
    ds_read_b64_tr_b16 v[130:131], v2 offset:512
    ds_read_b64_tr_b16 v[132:133], v3 offset:0
    ds_read_b64_tr_b16 v[134:135], v3 offset:512
    ds_read_b64_tr_b16 v[136:137], v2 offset:2048
    ds_read_b64_tr_b16 v[138:139], v2 offset:2560
    ds_read_b64_tr_b16 v[140:141], v3 offset:2048
    ds_read_b64_tr_b16 v[142:143], v3 offset:2560
    ds_read_b64_tr_b16 v[144:145], v2 offset:4096
    ds_read_b64_tr_b16 v[146:147], v2 offset:4608
    ds_read_b64_tr_b16 v[148:149], v3 offset:4096
    ds_read_b64_tr_b16 v[150:151], v3 offset:4608
L_sw_34:
    s_waitcnt lgkmcnt(3)
    s_cmp_eq_u32 s70, 9
    s_cbranch_scc1 L_sw_39
L_sw_38:
    ds_read_b64_tr_b16 v[224:225], v2 offset:49152
    ds_read_b64_tr_b16 v[226:227], v2 offset:49664
    ds_read_b64_tr_b16 v[228:229], v3 offset:49152
    ds_read_b64_tr_b16 v[230:231], v3 offset:49664
    ds_read_b64_tr_b16 v[232:233], v2 offset:51200
    ds_read_b64_tr_b16 v[234:235], v2 offset:51712
    ds_read_b64_tr_b16 v[236:237], v3 offset:51200
    ds_read_b64_tr_b16 v[238:239], v3 offset:51712
    ds_read_b64_tr_b16 v[240:241], v2 offset:53248
    ds_read_b64_tr_b16 v[242:243], v2 offset:53760
    ds_read_b64_tr_b16 v[244:245], v3 offset:53248
    ds_read_b64_tr_b16 v[246:247], v3 offset:53760
    s_branch L_sw_37
L_sw_39:
    ds_read_b64_tr_b16 v[152:153], v2 offset:49152
    ds_read_b64_tr_b16 v[154:155], v2 offset:49664
    ds_read_b64_tr_b16 v[156:157], v3 offset:49152
    ds_read_b64_tr_b16 v[158:159], v3 offset:49664
    ds_read_b64_tr_b16 v[160:161], v2 offset:51200
    ds_read_b64_tr_b16 v[162:163], v2 offset:51712
    ds_read_b64_tr_b16 v[164:165], v3 offset:51200
    ds_read_b64_tr_b16 v[166:167], v3 offset:51712
    ds_read_b64_tr_b16 v[168:169], v2 offset:53248
    ds_read_b64_tr_b16 v[170:171], v2 offset:53760
    ds_read_b64_tr_b16 v[172:173], v3 offset:53248
    ds_read_b64_tr_b16 v[174:175], v3 offset:53760
L_sw_37:
    s_waitcnt lgkmcnt(0)
    s_mov_b32 s48, s18
    s_mov_b32 s49, s19
    s_mov_b32 s50, 1024
    s_mov_b32 s51, 0x00020000
    s_waitcnt vmcnt(7)
    v_mfma_f32_32x32x16_bf16 v[40:55], v[104:107], v[8:11], 0
    v_mfma_f32_32x32x16_bf16 v[72:87], v[108:111], v[8:11], 0
    v_mfma_f32_32x32x16_bf16 v[56:71], v[104:107], v[12:15], 0
    v_mfma_f32_32x32x16_bf16 v[88:103], v[108:111], v[12:15], 0
    s_waitcnt vmcnt(5)
    v_mfma_f32_32x32x16_bf16 v[40:55], v[112:115], v[16:19], v[40:55]
    v_mfma_f32_32x32x16_bf16 v[72:87], v[116:119], v[16:19], v[72:87]
    v_mfma_f32_32x32x16_bf16 v[56:71], v[112:115], v[20:23], v[56:71]
    v_mfma_f32_32x32x16_bf16 v[88:103], v[116:119], v[20:23], v[88:103]
    s_waitcnt vmcnt(3)
    v_mfma_f32_32x32x16_bf16 v[40:55], v[120:123], v[24:27], v[40:55]
    v_mfma_f32_32x32x16_bf16 v[72:87], v[124:127], v[24:27], v[72:87]
    v_mfma_f32_32x32x16_bf16 v[56:71], v[120:123], v[28:31], v[56:71]
    v_mfma_f32_32x32x16_bf16 v[88:103], v[124:127], v[28:31], v[88:103]
    s_waitcnt vmcnt(1)
    v_mfma_f32_32x32x16_bf16 v[40:55], v[128:131], v[32:35], v[40:55]
    v_mfma_f32_32x32x16_bf16 v[72:87], v[132:135], v[32:35], v[72:87]
    v_mfma_f32_32x32x16_bf16 v[56:71], v[128:131], v[36:39], v[56:71]
    v_mfma_f32_32x32x16_bf16 v[88:103], v[132:135], v[36:39], v[88:103]
    s_branch L_pb1_c
L_pb1:
    buffer_load_dword v7, v251, s[40:43], 0 offen sc1
    s_add_u32 s66, s66, 1
    s_cmp_ge_u32 s66, 262144
    s_cbranch_scc1 L_pb1_d
L_pb1_c:
    s_waitcnt vmcnt(0)
    v_cmp_ne_u32 vcc, 1, v7
    s_cbranch_vccnz L_pb1
L_pb1_d:
    v_readlane_b32 s77, v248, 4
    s_mov_b32 s74, s77
    buffer_load_dwordx4 v[8:11], v252, s[40:43], s74 offen sc1
    buffer_load_dwordx4 v[12:15], v253, s[40:43], s74 offen sc1
    v_readlane_b32 s77, v248, 5
    s_mov_b32 s74, s77
    buffer_load_dwordx4 v[104:107], v252, s[40:43], s74 offen sc1
    buffer_load_dwordx4 v[108:111], v253, s[40:43], s74 offen sc1
    v_readlane_b32 s77, v248, 6
    s_mov_b32 s74, s77
    buffer_load_dwordx4 v[16:19], v252, s[40:43], s74 offen sc1
    buffer_load_dwordx4 v[20:23], v253, s[40:43], s74 offen sc1
    v_readlane_b32 s77, v248, 7
    s_mov_b32 s74, s77
    buffer_load_dwordx4 v[112:115], v252, s[40:43], s74 offen sc1
    buffer_load_dwordx4 v[116:119], v253, s[40:43], s74 offen sc1
    v_readlane_b32 s77, v248, 8
    s_mov_b32 s74, s77
    buffer_load_dwordx4 v[24:27], v252, s[40:43], s74 offen sc1
    buffer_load_dwordx4 v[28:31], v253, s[40:43], s74 offen sc1
    v_readlane_b32 s77, v248, 9
    s_mov_b32 s74, s77
    buffer_load_dwordx4 v[120:123], v252, s[40:43], s74 offen sc1
    buffer_load_dwordx4 v[124:127], v253, s[40:43], s74 offen sc1
    v_readlane_b32 s77, v248, 10
    s_mov_b32 s74, s77
    buffer_load_dwordx4 v[32:35], v252, s[40:43], s74 offen sc1
    buffer_load_dwordx4 v[36:39], v253, s[40:43], s74 offen sc1
    v_readlane_b32 s77, v248, 11
    s_mov_b32 s74, s77
    buffer_load_dwordx4 v[128:131], v252, s[40:43], s74 offen sc1
    buffer_load_dwordx4 v[132:135], v253, s[40:43], s74 offen sc1
    s_waitcnt vmcnt(14)
    v_mfma_f32_32x32x16_bf16 v[40:55], v[136:139], v[8:11], v[40:55]
    v_mfma_f32_32x32x16_bf16 v[72:87], v[140:143], v[8:11], v[72:87]
    v_mfma_f32_32x32x16_bf16 v[56:71], v[136:139], v[12:15], v[56:71]
    v_mfma_f32_32x32x16_bf16 v[88:103], v[140:143], v[12:15], v[88:103]
    buffer_load_dwordx4 v[2:5], v254, s[48:51], 0 offen
    s_waitcnt vmcnt(13)
    v_mfma_f32_32x32x16_bf16 v[40:55], v[144:147], v[104:107], v[40:55]
    v_mfma_f32_32x32x16_bf16 v[72:87], v[148:151], v[104:107], v[72:87]
    v_mfma_f32_32x32x16_bf16 v[56:71], v[144:147], v[108:111], v[56:71]
    v_mfma_f32_32x32x16_bf16 v[88:103], v[148:151], v[108:111], v[88:103]
    s_waitcnt vmcnt(11)
    v_mfma_f32_32x32x16_bf16 v[40:55], v[152:155], v[16:19], v[40:55]
    v_mfma_f32_32x32x16_bf16 v[72:87], v[156:159], v[16:19], v[72:87]
    v_mfma_f32_32x32x16_bf16 v[56:71], v[152:155], v[20:23], v[56:71]
    v_mfma_f32_32x32x16_bf16 v[88:103], v[156:159], v[20:23], v[88:103]
    v_readlane_b32 s77, v248, 12
    s_mov_b32 s74, s77
    buffer_load_dwordx4 v[8:11], v252, s[40:43], s74 offen sc1
    buffer_load_dwordx4 v[12:15], v253, s[40:43], s74 offen sc1
    s_waitcnt vmcnt(11)
    v_mfma_f32_32x32x16_bf16 v[40:55], v[160:163], v[112:115], v[40:55]
    v_mfma_f32_32x32x16_bf16 v[72:87], v[164:167], v[112:115], v[72:87]
    v_mfma_f32_32x32x16_bf16 v[56:71], v[160:163], v[116:119], v[56:71]
    v_mfma_f32_32x32x16_bf16 v[88:103], v[164:167], v[116:119], v[88:103]
    v_readlane_b32 s77, v248, 13
    s_mov_b32 s74, s77
    buffer_load_dwordx4 v[136:139], v252, s[40:43], s74 offen sc1
    buffer_load_dwordx4 v[140:143], v253, s[40:43], s74 offen sc1
    s_waitcnt vmcnt(11)
    v_mfma_f32_32x32x16_bf16 v[40:55], v[168:171], v[24:27], v[40:55]
    v_mfma_f32_32x32x16_bf16 v[72:87], v[172:175], v[24:27], v[72:87]
    v_mfma_f32_32x32x16_bf16 v[56:71], v[168:171], v[28:31], v[56:71]
    v_mfma_f32_32x32x16_bf16 v[88:103], v[172:175], v[28:31], v[88:103]
    v_readlane_b32 s77, v248, 14
    s_mov_b32 s74, s77
    buffer_load_dwordx4 v[104:107], v252, s[40:43], s74 offen sc1
    buffer_load_dwordx4 v[108:111], v253, s[40:43], s74 offen sc1
    s_waitcnt vmcnt(11)
    v_mfma_f32_32x32x16_bf16 v[40:55], v[176:179], v[120:123], v[40:55]
    v_mfma_f32_32x32x16_bf16 v[72:87], v[180:183], v[120:123], v[72:87]
    v_mfma_f32_32x32x16_bf16 v[56:71], v[176:179], v[124:127], v[56:71]
    v_mfma_f32_32x32x16_bf16 v[88:103], v[180:183], v[124:127], v[88:103]
    v_readlane_b32 s77, v248, 15
    s_mov_b32 s74, s77
    buffer_load_dwordx4 v[144:147], v252, s[40:43], s74 offen sc1
    buffer_load_dwordx4 v[148:151], v253, s[40:43], s74 offen sc1
    s_waitcnt vmcnt(11)
    v_mfma_f32_32x32x16_bf16 v[40:55], v[184:187], v[32:35], v[40:55]
    v_mfma_f32_32x32x16_bf16 v[72:87], v[188:191], v[32:35], v[72:87]
    v_mfma_f32_32x32x16_bf16 v[56:71], v[184:187], v[36:39], v[56:71]
    v_mfma_f32_32x32x16_bf16 v[88:103], v[188:191], v[36:39], v[88:103]
    v_readlane_b32 s77, v248, 16
    s_mov_b32 s74, s77
    buffer_load_dwordx4 v[16:19], v252, s[40:43], s74 offen sc1
    buffer_load_dwordx4 v[20:23], v253, s[40:43], s74 offen sc1
    s_waitcnt vmcnt(11)
    v_mfma_f32_32x32x16_bf16 v[40:55], v[192:195], v[128:131], v[40:55]
    v_mfma_f32_32x32x16_bf16 v[72:87], v[196:199], v[128:131], v[72:87]
    v_mfma_f32_32x32x16_bf16 v[56:71], v[192:195], v[132:135], v[56:71]
    v_mfma_f32_32x32x16_bf16 v[88:103], v[196:199], v[132:135], v[88:103]
    v_readlane_b32 s77, v248, 17
    s_mov_b32 s74, s77
    buffer_load_dwordx4 v[152:155], v252, s[40:43], s74 offen sc1
    buffer_load_dwordx4 v[156:159], v253, s[40:43], s74 offen sc1
    s_waitcnt vmcnt(10)
    v_mfma_f32_32x32x16_bf16 v[40:55], v[200:203], v[8:11], v[40:55]
    v_mfma_f32_32x32x16_bf16 v[72:87], v[204:207], v[8:11], v[72:87]
    v_mfma_f32_32x32x16_bf16 v[56:71], v[200:203], v[12:15], v[56:71]
    v_mfma_f32_32x32x16_bf16 v[88:103], v[204:207], v[12:15], v[88:103]
    s_waitcnt vmcnt(8)
    v_mfma_f32_32x32x16_bf16 v[40:55], v[208:211], v[136:139], v[40:55]
    v_mfma_f32_32x32x16_bf16 v[72:87], v[212:215], v[136:139], v[72:87]
    v_mfma_f32_32x32x16_bf16 v[56:71], v[208:211], v[140:143], v[56:71]
    v_mfma_f32_32x32x16_bf16 v[88:103], v[212:215], v[140:143], v[88:103]
    s_waitcnt vmcnt(6)
    v_mfma_f32_32x32x16_bf16 v[40:55], v[216:219], v[104:107], v[40:55]
    v_mfma_f32_32x32x16_bf16 v[72:87], v[220:223], v[104:107], v[72:87]
    v_mfma_f32_32x32x16_bf16 v[56:71], v[216:219], v[108:111], v[56:71]
    v_mfma_f32_32x32x16_bf16 v[88:103], v[220:223], v[108:111], v[88:103]
    s_waitcnt vmcnt(4)
    v_mfma_f32_32x32x16_bf16 v[40:55], v[224:227], v[144:147], v[40:55]
    v_mfma_f32_32x32x16_bf16 v[72:87], v[228:231], v[144:147], v[72:87]
    v_mfma_f32_32x32x16_bf16 v[56:71], v[224:227], v[148:151], v[56:71]
    v_mfma_f32_32x32x16_bf16 v[88:103], v[228:231], v[148:151], v[88:103]
    s_waitcnt vmcnt(2)
    v_mfma_f32_32x32x16_bf16 v[40:55], v[232:235], v[16:19], v[40:55]
    v_mfma_f32_32x32x16_bf16 v[72:87], v[236:239], v[16:19], v[72:87]
    v_mfma_f32_32x32x16_bf16 v[56:71], v[232:235], v[20:23], v[56:71]
    v_mfma_f32_32x32x16_bf16 v[88:103], v[236:239], v[20:23], v[88:103]
    s_waitcnt vmcnt(0)
    v_mfma_f32_32x32x16_bf16 v[40:55], v[240:243], v[152:155], v[40:55]
    v_mfma_f32_32x32x16_bf16 v[72:87], v[244:247], v[152:155], v[72:87]
    v_mfma_f32_32x32x16_bf16 v[56:71], v[240:243], v[156:159], v[56:71]
    v_mfma_f32_32x32x16_bf16 v[88:103], v[244:247], v[156:159], v[88:103]
L_red:
    v_and_b32 v104, 31, v0
    v_lshrrev_b32 v105, 5, v0
    v_and_b32 v106, 7, v0
    v_xor_b32 v105, v105, v106
    v_lshlrev_b32 v105, 4, v105
    v_lshl_add_u32 v105, v104, 8, v105
    v_add_u32 v105, s65, v105
    v_mov_b32 v107, 43008
    v_cmp_le_u32 vcc, 24, v104
    v_add_u32 v112, 51200, v105
    v_lshrrev_b32 v120, 3, v0
    v_cndmask_b32 v108, 0, v107, vcc
    v_cmp_le_u32 vcc, 16, v104
    v_add_u32 v108, v108, v105
    v_lshlrev_b32 v121, 1, v106
    v_cndmask_b32 v107, 0, v107, vcc
    v_add_u32 v112, v112, v107
    v_xor_b32 v109, 32, v108
    v_xor_b32 v110, 64, v108
    v_xor_b32 v111, 0x60, v108
    v_xor_b32 v113, 32, v112
    v_xor_b32 v114, 64, v112
    v_xor_b32 v115, 0x60, v112
    ds_write_b128 v108, v[40:43] offset:0
    ds_write_b128 v109, v[44:47] offset:0
    ds_write_b128 v110, v[48:51] offset:0
    ds_write_b128 v111, v[52:55] offset:0
    ds_write_b128 v108, v[72:75] offset:128
    ds_write_b128 v109, v[76:79] offset:128
    ds_write_b128 v110, v[80:83] offset:128
    ds_write_b128 v111, v[84:87] offset:128
    ds_write_b128 v112, v[56:59] offset:0
    ds_write_b128 v113, v[60:63] offset:0
    ds_write_b128 v114, v[64:67] offset:0
    ds_write_b128 v115, v[68:71] offset:0
    s_waitcnt lgkmcnt(4)
    ds_write_b128 v112, v[88:91] offset:128
    ds_write_b128 v113, v[92:95] offset:128
    ds_write_b128 v114, v[96:99] offset:128
    ds_write_b128 v115, v[100:103] offset:128
    v_xor_b32 v121, v121, v120
    v_lshlrev_b32 v121, 4, v121
    s_lshl_b32 s77, s3, 3
    v_add_u32 v120, s77, v120
    v_lshl_add_u32 v116, v120, 8, v121
    s_mul_i32 s77, s3, 43
    s_lshr_b32 s77, s77, 7
    s_mul_i32 s77, s77, 43008
    v_add_u32 v116, s77, v116
    v_xor_b32 v117, 16, v116
    v_lshlrev_b32 v118, 2, v120
    v_add_u32 v118, 157696, v118
    v_add_u32 v120, s67, v120
    v_lshl_add_u32 v120, v120, 1, s56
    v_lshl_add_u32 v120, v120, 10, v254
    s_cmp_lg_u32 s3, 0
    s_cbranch_scc1 L_ng3
    v_add_f32 v255, 1.0, v255
    v_lshlrev_b32 v119, 2, v0
    v_rcp_f32 v255, v255
    v_add_u32 v119, 157696, v119
    ds_write_b32 v119, v255
L_ng3:
    s_waitcnt vmcnt(0)
    v_lshlrev_b32 v8, 16, v2
    v_and_b32 v9, 0xffff0000, v2
    v_lshlrev_b32 v10, 16, v3
    v_and_b32 v11, 0xffff0000, v3
    v_lshlrev_b32 v12, 16, v4
    v_and_b32 v13, 0xffff0000, v4
    v_lshlrev_b32 v14, 16, v5
    v_and_b32 v15, 0xffff0000, v5
    s_waitcnt lgkmcnt(0)
    s_barrier
    ds_read_b32 v121, v118
    ds_read_b128 v[128:131], v116 offset:0
    ds_read_b128 v[132:135], v117 offset:0
    ds_read_b128 v[136:139], v116 offset:6144
    ds_read_b128 v[140:143], v117 offset:6144
    ds_read_b128 v[144:147], v116 offset:12288
    ds_read_b128 v[148:151], v117 offset:12288
    ds_read_b128 v[152:155], v116 offset:18432
    ds_read_b128 v[156:159], v117 offset:18432
    ds_read_b128 v[160:163], v116 offset:24576
    ds_read_b128 v[164:167], v117 offset:24576
    ds_read_b128 v[168:171], v116 offset:30720
    ds_read_b128 v[172:175], v117 offset:30720
    ds_read_b128 v[176:179], v116 offset:36864
    ds_read_b128 v[180:183], v117 offset:36864
    s_waitcnt lgkmcnt(12)
    ds_read_b128 v[184:187], v116 offset:43008
    ds_read_b128 v[188:191], v117 offset:43008
    v_pk_add_f32 v[8:9], v[8:9], v[128:129]
    v_pk_add_f32 v[10:11], v[10:11], v[130:131]
    v_pk_add_f32 v[12:13], v[12:13], v[132:133]
    v_pk_add_f32 v[14:15], v[14:15], v[134:135]
    s_waitcnt lgkmcnt(12)
    v_pk_add_f32 v[8:9], v[8:9], v[136:137]
    v_pk_add_f32 v[10:11], v[10:11], v[138:139]
    v_pk_add_f32 v[12:13], v[12:13], v[140:141]
    v_pk_add_f32 v[14:15], v[14:15], v[142:143]
    s_waitcnt lgkmcnt(10)
    v_pk_add_f32 v[8:9], v[8:9], v[144:145]
    v_pk_add_f32 v[10:11], v[10:11], v[146:147]
    v_pk_add_f32 v[12:13], v[12:13], v[148:149]
    v_pk_add_f32 v[14:15], v[14:15], v[150:151]
    s_waitcnt lgkmcnt(8)
    v_pk_add_f32 v[8:9], v[8:9], v[152:153]
    v_pk_add_f32 v[10:11], v[10:11], v[154:155]
    v_pk_add_f32 v[12:13], v[12:13], v[156:157]
    v_pk_add_f32 v[14:15], v[14:15], v[158:159]
    s_waitcnt lgkmcnt(6)
    v_pk_add_f32 v[8:9], v[8:9], v[160:161]
    v_pk_add_f32 v[10:11], v[10:11], v[162:163]
    v_pk_add_f32 v[12:13], v[12:13], v[164:165]
    v_pk_add_f32 v[14:15], v[14:15], v[166:167]
    s_waitcnt lgkmcnt(4)
    v_pk_add_f32 v[8:9], v[8:9], v[168:169]
    v_pk_add_f32 v[10:11], v[10:11], v[170:171]
    v_pk_add_f32 v[12:13], v[12:13], v[172:173]
    v_pk_add_f32 v[14:15], v[14:15], v[174:175]
    s_waitcnt lgkmcnt(2)
    v_pk_add_f32 v[8:9], v[8:9], v[176:177]
    v_pk_add_f32 v[10:11], v[10:11], v[178:179]
    v_pk_add_f32 v[12:13], v[12:13], v[180:181]
    v_pk_add_f32 v[14:15], v[14:15], v[182:183]
    s_waitcnt lgkmcnt(0)
    v_pk_add_f32 v[8:9], v[8:9], v[184:185]
    v_pk_add_f32 v[10:11], v[10:11], v[186:187]
    v_pk_add_f32 v[12:13], v[12:13], v[188:189]
    v_pk_add_f32 v[14:15], v[14:15], v[190:191]
    v_mul_f32 v8, v8, v121
    v_mul_f32 v9, v9, v121
    v_mul_f32 v10, v10, v121
    v_mul_f32 v11, v11, v121
    v_mul_f32 v12, v12, v121
    v_mul_f32 v13, v13, v121
    v_mul_f32 v14, v14, v121
    v_mul_f32 v15, v15, v121
    v_cvt_pk_bf16_f32 v16, v8, v9
    v_cvt_pk_bf16_f32 v17, v10, v11
    v_cvt_pk_bf16_f32 v18, v12, v13
    v_cvt_pk_bf16_f32 v19, v14, v15
    buffer_store_dwordx4 v[16:19], v120, s[44:47], 0 offen
L_end:
    s_endpgm
.section .rodata,"a"
.p2align 6
.amdhsa_kernel gated_mix__sliding_local_dilated__dense_activation_gelu__prompt_kernel
  .amdhsa_next_free_vgpr 256
  .amdhsa_next_free_sgpr 102
  .amdhsa_accum_offset 256
  .amdhsa_group_segment_fixed_size 0
  .amdhsa_kernarg_size 96
  .amdhsa_user_sgpr_count 2
  .amdhsa_user_sgpr_kernarg_segment_ptr 1
  .amdhsa_system_sgpr_workgroup_id_x 1
.end_amdhsa_kernel
```
